```python
import torch

def _softmax(x, axis=-1):
    return torch.softmax(x, dim=axis)
def _gelu(x):
    return torch.nn.functional.gelu(x, approximate="tanh")
def _silu(x):
    return torch.nn.functional.silu(x)
def _sigmoid(x):
    return torch.sigmoid(x)
def _layernorm(x, axis=-1, eps=1e-5):
    m = x.mean(dim=axis, keepdim=True)
    v = x.var(dim=axis, keepdim=True, unbiased=False)
    return (x - m) / torch.sqrt(v + eps)
def _scatter_add(tgt, idx, src, axis=0):
    return tgt.clone().index_add_(axis, idx, src)
def _segment_sum(src, seg, n):
    out = torch.zeros((n,) + src.shape[1:], dtype=src.dtype)
    return out.index_add_(0, seg, src)
def _pad(x, pw):
    flat = tuple(v for pair in reversed(pw) for v in pair)
    return torch.nn.functional.pad(x, flat)

kernel_name = 'gated_mix__sliding_block_cached__swiglu_ffn__decode'

def setup_inputs():

    _w = (lambda a: (lambda t: t.to(torch.bfloat16) if t.is_floating_point() else t)(torch.as_tensor(a)))
    def _A_setup():
        B, Sq, D = 2, 1, 640
        Hq, Hkv, Sk, Dh = 32, 32, 8192, 192
        assert Hq % Hkv == 0, (Hq, Hkv)
        return {
            "x": _w((lambda *s: torch.randn(*s, dtype=torch.bfloat16) * 0.05)(B, Sq, D)),
            "k_cache": _w((lambda *s: torch.randn(*s, dtype=torch.bfloat16) * 6.4)(B, Hkv, Sk, Dh)),
            "v_cache": _w((lambda *s: torch.randn(*s, dtype=torch.bfloat16) * 0.4)(B, Hkv, Sk, Dh)),
            "wq": _w((lambda *s: torch.randn(*s, dtype=torch.bfloat16) * 6.4)(D, Hq * Dh) * (D ** -0.5)),
            "wo": _w((lambda *s: torch.randn(*s, dtype=torch.bfloat16) * 0.4)(Hq * Dh, D) * ((Hq * Dh) ** -0.5)),
        }
    _A_in = _A_setup()

    def _B_setup():
        B, S, D, F = 2, 1, 640, 1536
        return {
            "x": _w((lambda *s: torch.randn(*s, dtype=torch.bfloat16) * 0.05)(B, S, D)),
            "w_gate": _w((lambda *s: torch.randn(*s, dtype=torch.bfloat16) * 0.05)(D, F)),
            "w_up": _w((lambda *s: torch.randn(*s, dtype=torch.bfloat16) * 0.05)(D, F)),
            "w_down": _w((lambda *s: torch.randn(*s, dtype=torch.bfloat16) * 0.05)(F, D)),
        }
    _B_in = _B_setup()

    return {
        "A_x": _A_in["x"],
        "A_k_cache": _A_in["k_cache"],
        "A_v_cache": _A_in["v_cache"],
        "A_wq": _A_in["wq"],
        "A_wo": _A_in["wo"],
        "B_x": _B_in["x"],
        "B_w_gate": _B_in["w_gate"],
        "B_w_up": _B_in["w_up"],
        "B_w_down": _B_in["w_down"],
        "gate_w": _w((lambda *s: torch.randn(*s, dtype=torch.bfloat16) * 0.05)(640) * 16.0),
    }

def reference(A_x, A_k_cache, A_v_cache, A_wq, A_wo, B_x, B_w_gate, B_w_up, B_w_down, gate_w):
    def _A_ref(x, k_cache, v_cache, wq, wo):
        B, Sq, D = x.shape
        Hq, Dh = 32, 192
        Hkv, Sk = k_cache.shape[1], k_cache.shape[2]
        W = min(4096, max(256, Sk // 4))
        rep = Hq // Hkv
        q = (lambda x, *d: x.permute(*d))((x @ wq).reshape(B, Sq, Hq, Dh), 0, 2, 1, 3)
        k = (lambda x, n, axis: torch.repeat_interleave(x, n, dim=axis))(k_cache[:, :, Sk - W:, :], rep, axis=1)
        v = (lambda x, n, axis: torch.repeat_interleave(x, n, dim=axis))(v_cache[:, :, Sk - W:, :], rep, axis=1)
        scores = torch.einsum("bhqd,bhkd->bhqk", q, k) * (Dh ** -0.5)
        p = _softmax(scores, axis=-1)
        o = torch.einsum("bhqk,bhkd->bhqd", p, v)
        return (lambda x, *d: x.permute(*d))(o, 0, 2, 1, 3).reshape(B, Sq, Hq * Dh) @ wo

    def _B_ref(x, w_gate, w_up, w_down):
        g = _silu(x @ w_gate)
        u = x @ w_up
        return (g * u) @ w_down

    x = A_x
    g = _sigmoid((x * gate_w).sum(-1, keepdims=True))
    a = _A_ref(x, A_k_cache, A_v_cache, A_wq, A_wo)
    b = _B_ref(x, B_w_gate, B_w_up, B_w_down)
    return g * a + (1 - g) * b
```

```asm
; @launch grid=(256,1,1) block=(256,1,1) lds=107520
.amdgcn_target "amdgcn-amd-amdhsa--gfx950"
.text
.globl gated_mix__sliding_block_cached__swiglu_ffn__decode_kernel
.p2align 8
.type gated_mix__sliding_block_cached__swiglu_ffn__decode_kernel,@function
gated_mix__sliding_block_cached__swiglu_ffn__decode_kernel:
    s_cmp_ge_u32 s2, 0x100
    s_cbranch_scc1 END
    s_load_dwordx2 s[48:49], s[0:1], 96
    s_load_dwordx2 s[36:37], s[0:1], 0
    s_load_dwordx2 s[12:13], s[0:1], 24
    s_load_dwordx2 s[20:21], s[0:1], 48
    s_load_dwordx2 s[24:25], s[0:1], 56
    s_load_dwordx2 s[4:5], s[0:1], 8
    s_load_dwordx2 s[32:33], s[0:1], 72
    s_load_dwordx2 s[8:9], s[0:1], 16
    s_load_dwordx2 s[44:45], s[0:1], 88
    s_load_dwordx2 s[16:17], s[0:1], 32
    s_load_dwordx2 s[28:29], s[0:1], 64
    s_load_dwordx2 s[40:41], s[0:1], 80
    s_getpc_b64 s[52:53]
PCREF:
    v_lshlrev_b32 v3, 7, v0
    v_min_u32 v3, END-PCREF, v3
    global_load_dword v63, v3, s[52:53]
    v_lshrrev_b32 v4, 6, v0
    v_and_b32 v1, 63, v0
    v_readfirstlane_b32 s54, v4
    s_mov_b32 s6, 201326592
    s_mov_b32 s7, 0x20000
    s_and_b32 s3, s2, 7
    s_lshr_b32 s66, s2, 6
    s_lshl_b32 s3, s3, 2
    s_add_u32 s55, s3, s66
    s_bfe_u32 s56, s2, 0x30003
    s_lshr_b32 s57, s56, 2
    s_lshl_b32 s3, s57, 5
    s_add_u32 s3, s3, s55
    s_mul_i32 s59, s3, 3145728
    s_and_b32 s3, s56, 3
    s_mul_i32 s3, s3, 196608
    s_add_u32 s59, s59, s3
    s_mul_i32 s3, s54, 49152
    s_add_u32 s3, s3, 2359296
    s_add_u32 s59, s59, s3
    s_mov_b32 s58, s59
    v_lshrrev_b32 v4, 3, v1
    v_mul_u32_u24 v5, 384, v4
    v_and_b32 v6, 7, v1
    v_lshl_add_u32 v2, v6, 4, v5
    s_waitcnt lgkmcnt(0)
    buffer_load_dwordx4 v[64:67], v2, s[4:7], s58 offen offset:0 nt
    buffer_load_dwordx4 v[68:71], v2, s[4:7], s58 offen offset:128 nt
    buffer_load_dwordx4 v[72:75], v2, s[4:7], s58 offen offset:256 nt
    buffer_load_dwordx4 v[76:79], v2, s[4:7], s58 offen offset:3072 nt
    buffer_load_dwordx4 v[80:83], v2, s[4:7], s58 offen offset:3200 nt
    buffer_load_dwordx4 v[84:87], v2, s[4:7], s58 offen offset:3328 nt
    s_mov_b32 s50, 3276800
    s_mov_b32 s51, 0x20000
    s_mov_b32 s38, 2560
    s_mov_b32 s39, 0x20000
    s_mov_b32 s14, 7864320
    s_mov_b32 s15, 0x20000
    s_mov_b32 s22, 1966080
    s_mov_b32 s23, 0x20000
    s_mov_b32 s26, 1966080
    s_mov_b32 s27, 0x20000
    s_mov_b32 s34, 1280
    s_mov_b32 s35, 0x20000
    s_mov_b32 s10, 201326592
    s_mov_b32 s11, 0x20000
    s_mov_b32 s46, 256
    s_mov_b32 s47, 0x20000
    s_mov_b32 s18, 7864320
    s_mov_b32 s19, 0x20000
    s_mov_b32 s30, 1966080
    s_mov_b32 s31, 0x20000
    s_mov_b32 s42, 2560
    s_mov_b32 s43, 0x20000
    s_mul_i32 s96, s56, 160
    s_mul_i32 s60, s56, 983040
    s_mul_i32 s3, s55, 384
    s_add_u32 s60, s60, s3
    s_mul_i32 s61, s56, 245760
    s_mul_i32 s3, s55, 96
    s_add_u32 s61, s61, s3
    s_lshl_b32 s100, s54, 10
    s_lshl_b32 s3, s55, 3
    s_add_u32 s3, s3, s56
    s_mul_i32 s64, s3, 2304
    s_lshl_b32 s65, s55, 12
    s_add_u32 s65, s65, 1048576
    s_mov_b32 s101, 0xffff0000
    s_mov_b32 s67, 65536
    s_lshl_b32 s98, s56, 14
    s_lshl_b32 s3, s55, 7
    s_add_u32 s98, s98, s3
    s_add_u32 s98, s98, 1179648
    s_lshl_b32 s99, s57, 16
    s_lshl_b32 s3, s55, 9
    s_add_u32 s99, s99, s3
    s_and_b32 s3, s56, 3
    s_lshl_b32 s3, s3, 7
    s_add_u32 s99, s99, s3
    s_add_u32 s99, s99, 1310720
    s_add_u32 s52, s64, s100
    s_lshl_b32 s3, s56, 9
    s_add_u32 s3, s3, s65
    s_sub_u32 s3, s3, s64
    s_sub_u32 s3, s3, 2304
    s_cmp_eq_u32 s54, 2
    s_cselect_b32 s53, s3, 0
    s_cselect_b32 s66, 1073741824, 0
    s_sub_u32 s3, s99, s98
    s_sub_u32 s3, s3, 65536
    s_cmp_eq_u32 s54, 3
    s_cselect_b32 s52, s98, s52
    s_cselect_b32 s53, s3, s53
    s_cselect_b32 s62, 3968, 0
    s_cselect_b32 s63, 31, 15
    s_cselect_b32 s3, 16256, 0
    v_mov_b32 v5, s62
    v_mov_b32 v6, s3
    v_mov_b32 v7, s53
    v_cmp_lt_u32 vcc, s63, v1
    v_mov_b32 v36, -1
    v_mov_b32 v37, -1
    v_cndmask_b32 v5, v5, v6, vcc
    v_cndmask_b32 v7, 0, v7, vcc
    v_mov_b32 v6, s66
    v_mul_u32_u24 v4, v5, v4
    v_cmp_lt_u32 vcc, 47, v1
    v_add3_u32 v4, s52, v4, v7
    v_lshl_add_u32 v35, v1, 4, v4
    v_cndmask_b32 v6, 0, v6, vcc
    v_mov_b32 v38, -1
    v_mov_b32 v39, -1
    v_add_u32 v35, v35, v6
    v_lshrrev_b32 v15, 4, v1
    v_bfe_u32 v16, v1, 2, 1
    v_lshrrev_b32 v17, 2, v1
    v_and_b32 v18, 3, v1
    v_mul_u32_u24 v4, 0x500, v16
    v_lshl_add_u32 v7, v15, 3, v4
    v_add_u32 v4, 0, v0
    v_mul_u32_u24 v5, 43691, v4
    v_lshrrev_b32 v5, 20, v5
    v_mul_u32_u24 v6, 24, v5
    v_sub_u32 v4, v4, v6
    v_and_b32 v6, 6, v5
    v_xor_b32 v4, v4, v6
    v_mul_u32_u24 v5, 12288, v5
    v_lshl_add_u32 v30, v4, 4, v5
    v_add_u32 v4, 256, v0
    v_mul_u32_u24 v5, 43691, v4
    v_lshrrev_b32 v5, 20, v5
    v_mul_u32_u24 v6, 24, v5
    v_sub_u32 v4, v4, v6
    v_and_b32 v6, 6, v5
    v_xor_b32 v4, v4, v6
    v_mul_u32_u24 v5, 12288, v5
    v_lshl_add_u32 v31, v4, 4, v5
    v_add_u32 v4, 512, v0
    v_mul_u32_u24 v5, 43691, v4
    v_lshrrev_b32 v5, 20, v5
    v_mul_u32_u24 v6, 24, v5
    v_sub_u32 v4, v4, v6
    v_and_b32 v6, 6, v5
    v_xor_b32 v4, v4, v6
    v_mul_u32_u24 v5, 12288, v5
    v_lshl_add_u32 v32, v4, 4, v5
    v_add_u32 v4, 0, v0
    v_mul_u32_u24 v5, 10923, v4
    v_lshrrev_b32 v5, 16, v5
    v_mul_u32_u24 v5, 2976, v5
    v_lshl_add_u32 v33, v4, 4, v5
    v_add_u32 v4, 256, v0
    v_mul_u32_u24 v5, 10923, v4
    v_lshrrev_b32 v5, 16, v5
    v_mul_u32_u24 v5, 2976, v5
    v_lshl_add_u32 v34, v4, 4, v5
    s_mov_b32 m0, s100
    s_cmp_eq_u32 s54, 3
    s_cselect_b32 s53, 0, 2097152
    buffer_store_dwordx4 v[36:39], v35, s[48:51], s53 offen sc1
    s_cmp_eq_u32 s54, 3
    s_cbranch_scc1 SKIP_CLR
    buffer_store_dwordx4 v[36:39], v35, s[48:51], 0 offen
SKIP_CLR:
    s_and_b32 s3, s2, 7
    s_lshl_b32 s3, s3, 7
    s_add_u32 s3, s3, 1572864
    v_and_b32 v12, 31, v1
    v_lshl_add_u32 v12, v12, 2, s3
    s_lshr_b32 s53, s2, 3
    s_lshl_b32 s53, s53, 2
    s_add_u32 s3, s3, s53
    s_add_u32 s3, s3, s54
    v_mov_b32 v14, s3
    v_mov_b32 v13, 0
    v_mov_b32 v19, 1
    buffer_store_byte v13, v14, s[48:51], 0 offen offset:0
    buffer_store_byte v13, v14, s[48:51], 0 offen offset:1024
    buffer_load_dwordx2 v[20:21], v7, s[36:39], s96 offen offset:0
    buffer_load_dwordx2 v[22:23], v7, s[36:39], s96 offen offset:32
    buffer_load_dwordx2 v[24:25], v7, s[36:39], s96 offen offset:64
    buffer_load_dwordx2 v[26:27], v7, s[36:39], s96 offen offset:96
    buffer_load_dwordx2 v[28:29], v7, s[36:39], s96 offen offset:128
    buffer_load_dwordx4 v30, s[12:15], s60 offen nt lds
    s_add_u32 m0, m0, 4096
    s_nop 0
    buffer_load_dwordx4 v31, s[12:15], s60 offen nt lds
    s_add_u32 m0, m0, 4096
    s_nop 0
    buffer_load_dwordx4 v32, s[12:15], s60 offen nt lds
    s_add_u32 m0, m0, 4096
    s_add_u32 s60, s60, 393216
    buffer_load_dwordx4 v30, s[12:15], s60 offen nt lds
    s_add_u32 m0, m0, 4096
    s_nop 0
    buffer_load_dwordx4 v31, s[12:15], s60 offen nt lds
    s_add_u32 m0, m0, 4096
    s_nop 0
    buffer_load_dwordx4 v32, s[12:15], s60 offen nt lds
    s_add_u32 m0, m0, 4096
    s_add_u32 s60, s60, 393216
    buffer_load_dwordx4 v30, s[12:15], s60 offen nt lds
    s_add_u32 m0, m0, 4096
    s_cmp_ge_u32 s54, 2
    s_cbranch_scc1 SKIP_WQ7
    buffer_load_dwordx4 v31, s[12:15], s60 offen nt lds
SKIP_WQ7:
    s_add_u32 m0, s100, 30720
    s_nop 0
    buffer_load_dwordx4 v33, s[20:23], s61 offen nt lds
    s_add_u32 m0, m0, 4096
    s_nop 0
    buffer_load_dwordx4 v34, s[20:23], s61 offen nt lds
    s_add_u32 m0, m0, 4096
    s_nop 0
    buffer_load_dwordx4 v33, s[24:27], s61 offen nt lds
    s_add_u32 m0, m0, 4096
    s_nop 0
    buffer_load_dwordx4 v34, s[24:27], s61 offen nt lds
    s_cmp_lg_u32 s54, 3
    s_cbranch_scc1 SKIP_GL
    v_and_b32 v4, 31, v1
    v_lshrrev_b32 v5, 5, v1
    v_cmp_gt_u32 vcc, 16, v4
    v_lshlrev_b32 v4, 4, v4
    v_mul_u32_u24 v5, 0x500, v5
    v_add_u32 v5, v5, v4
    v_mov_b32 v6, 1073741824
    v_cndmask_b32 v6, v6, v5, vcc
    buffer_load_dwordx4 v[40:43], v5, s[36:39], 0 offen offset:0
    buffer_load_dwordx4 v[52:55], v4, s[32:35], 0 offen offset:0
    buffer_load_dwordx4 v[44:47], v5, s[36:39], 0 offen offset:512
    buffer_load_dwordx4 v[56:59], v4, s[32:35], 0 offen offset:512
    buffer_load_dwordx4 v[48:51], v6, s[36:39], 0 offen offset:1024
    buffer_load_dwordx4 v[60:63], v4, s[32:35], 0 offen offset:1024
SKIP_GL:
    s_add_u32 s58, s58, 6144
    buffer_load_dwordx4 v[88:91], v2, s[4:7], s58 offen offset:0 nt
    buffer_load_dwordx4 v[92:95], v2, s[4:7], s58 offen offset:128 nt
    buffer_load_dwordx4 v[96:99], v2, s[4:7], s58 offen offset:256 nt
    buffer_load_dwordx4 v[100:103], v2, s[4:7], s58 offen offset:3072 nt
    buffer_load_dwordx4 v[104:107], v2, s[4:7], s58 offen offset:3200 nt
    buffer_load_dwordx4 v[108:111], v2, s[4:7], s58 offen offset:3328 nt
    s_add_u32 s58, s58, 6144
    buffer_load_dwordx4 v[112:115], v2, s[4:7], s58 offen offset:0 nt
    buffer_load_dwordx4 v[116:119], v2, s[4:7], s58 offen offset:128 nt
    buffer_load_dwordx4 v[120:123], v2, s[4:7], s58 offen offset:256 nt
    buffer_load_dwordx4 v[124:127], v2, s[4:7], s58 offen offset:3072 nt
    buffer_load_dwordx4 v[128:131], v2, s[4:7], s58 offen offset:3200 nt
    buffer_load_dwordx4 v[132:135], v2, s[4:7], s58 offen offset:3328 nt
    s_add_u32 s58, s58, 6144
    buffer_load_dwordx4 v[136:139], v2, s[4:7], s58 offen offset:0 nt
    buffer_load_dwordx4 v[140:143], v2, s[4:7], s58 offen offset:128 nt
    buffer_load_dwordx4 v[144:147], v2, s[4:7], s58 offen offset:256 nt
    buffer_load_dwordx4 v[148:151], v2, s[4:7], s58 offen offset:3072 nt
    buffer_load_dwordx4 v[152:155], v2, s[4:7], s58 offen offset:3200 nt
    buffer_load_dwordx4 v[156:159], v2, s[4:7], s58 offen offset:3328 nt
    s_lshl_b32 s3, s54, 1
    s_lshl_b32 s66, s54, 5
    s_add_u32 s66, s66, 30720
    v_lshrrev_b32 v4, 1, v18
    v_add_u32 v4, s3, v4
    v_and_b32 v5, 6, v17
    v_xor_b32 v4, v4, v5
    v_mul_u32_u24 v5, 384, v17
    v_lshl_add_u32 v4, v4, 4, v5
    v_and_b32 v5, 1, v18
    v_lshl_add_u32 v30, v5, 3, v4
    v_mul_u32_u24 v4, 96, v17
    v_lshl_add_u32 v4, v18, 3, v4
    v_add_u32 v31, s66, v4
    v_mul_u32_u24 v4, 768, v16
    v_lshl_add_u32 v10, v15, 4, v4
    v_mul_u32_u24 v4, 192, v16
    v_lshl_add_u32 v11, v15, 4, v4
    s_lshl_b32 s3, s54, 6
    s_add_u32 s64, s64, s3
    s_getreg_b32 s3, hwreg(HW_REG_XCC_ID, 0, 4)
    s_mul_i32 s66, s3, s3
    s_lshl_b32 s66, s66, 8
    s_add_u32 s3, s3, s66
    s_lshl_b32 s3, s3, 8
    s_add_u32 s60, s3, 1
    s_waitcnt vmcnt(18)
    s_barrier
    s_cmp_lg_u32 s54, 0
    s_cbranch_scc1 SKIP_AT
    s_lshl_b32 s3, s55, 2
    v_mov_b32 v4, s60
    s_mov_b32 exec_lo, 0x1
    s_mov_b32 exec_hi, 0x0
    buffer_atomic_add v4, off, s[44:47], s3 offset:0
    s_mov_b64 exec, -1
SKIP_AT:
    ds_read_b64_tr_b16 a[0:1], v30 offset:0
    ds_read_b64_tr_b16 a[2:3], v30 offset:128
    ds_read_b64_tr_b16 a[4:5], v30 offset:256
    ds_read_b64_tr_b16 a[6:7], v30 offset:6144
    ds_read_b64_tr_b16 a[8:9], v30 offset:6272
    ds_read_b64_tr_b16 a[10:11], v30 offset:6400
    ds_read_b64_tr_b16 a[12:13], v30 offset:12288
    ds_read_b64_tr_b16 a[14:15], v30 offset:12416
    ds_read_b64_tr_b16 a[16:17], v30 offset:12544
    ds_read_b64_tr_b16 a[18:19], v30 offset:18432
    ds_read_b64_tr_b16 a[20:21], v30 offset:18560
    ds_read_b64_tr_b16 a[22:23], v30 offset:18688
    ds_read_b64_tr_b16 a[24:25], v30 offset:24576
    ds_read_b64_tr_b16 a[26:27], v30 offset:24704
    ds_read_b64_tr_b16 a[28:29], v30 offset:24832
    s_add_u32 s58, s58, 6144
    buffer_load_dwordx4 v[160:163], v2, s[4:7], s58 offen offset:0 nt
    buffer_load_dwordx4 v[164:167], v2, s[4:7], s58 offen offset:128 nt
    buffer_load_dwordx4 v[168:171], v2, s[4:7], s58 offen offset:256 nt
    buffer_load_dwordx4 v[172:175], v2, s[4:7], s58 offen offset:3072 nt
    buffer_load_dwordx4 v[176:179], v2, s[4:7], s58 offen offset:3200 nt
    buffer_load_dwordx4 v[180:183], v2, s[4:7], s58 offen offset:3328 nt
    s_cmp_eq_u32 s54, 3
    s_cbranch_scc1 GATE
    ds_read_b64_tr_b16 a[30:31], v31 offset:0
    ds_read_b64_tr_b16 a[32:33], v31 offset:8192
    ds_read_b64_tr_b16 a[34:35], v31 offset:1536
    ds_read_b64_tr_b16 a[36:37], v31 offset:9728
    ds_read_b64_tr_b16 a[38:39], v31 offset:3072
    ds_read_b64_tr_b16 a[40:41], v31 offset:11264
    ds_read_b64_tr_b16 a[42:43], v31 offset:4608
    ds_read_b64_tr_b16 a[44:45], v31 offset:12800
    ds_read_b64_tr_b16 a[46:47], v31 offset:6144
    ds_read_b64_tr_b16 a[48:49], v31 offset:14336
    s_waitcnt lgkmcnt(10)
    v_mfma_f32_16x16x16_bf16 a[192:195], a[0:1], v[20:21], 0
    v_mfma_f32_16x16x16_bf16 a[196:199], a[2:3], v[20:21], 0
    v_mfma_f32_16x16x16_bf16 a[200:203], a[4:5], v[20:21], 0
    v_mfma_f32_16x16x16_bf16 a[192:195], a[6:7], v[22:23], a[192:195]
    v_mfma_f32_16x16x16_bf16 a[196:199], a[8:9], v[22:23], a[196:199]
    v_mfma_f32_16x16x16_bf16 a[200:203], a[10:11], v[22:23], a[200:203]
    v_mfma_f32_16x16x16_bf16 a[192:195], a[12:13], v[24:25], a[192:195]
    v_mfma_f32_16x16x16_bf16 a[196:199], a[14:15], v[24:25], a[196:199]
    v_mfma_f32_16x16x16_bf16 a[200:203], a[16:17], v[24:25], a[200:203]
    v_mfma_f32_16x16x16_bf16 a[192:195], a[18:19], v[26:27], a[192:195]
    v_mfma_f32_16x16x16_bf16 a[196:199], a[20:21], v[26:27], a[196:199]
    v_mfma_f32_16x16x16_bf16 a[200:203], a[22:23], v[26:27], a[200:203]
    v_mfma_f32_16x16x16_bf16 a[192:195], a[24:25], v[28:29], a[192:195]
    v_mfma_f32_16x16x16_bf16 a[196:199], a[26:27], v[28:29], a[196:199]
    v_mfma_f32_16x16x16_bf16 a[200:203], a[28:29], v[28:29], a[200:203]
    s_waitcnt lgkmcnt(0)
    v_mfma_f32_16x16x16_bf16 a[204:207], a[30:31], v[20:21], 0
    v_mfma_f32_16x16x16_bf16 a[208:211], a[32:33], v[20:21], 0
    v_mfma_f32_16x16x16_bf16 a[204:207], a[34:35], v[22:23], a[204:207]
    v_mfma_f32_16x16x16_bf16 a[208:211], a[36:37], v[22:23], a[208:211]
    v_mfma_f32_16x16x16_bf16 a[204:207], a[38:39], v[24:25], a[204:207]
    v_mfma_f32_16x16x16_bf16 a[208:211], a[40:41], v[24:25], a[208:211]
    v_mfma_f32_16x16x16_bf16 a[204:207], a[42:43], v[26:27], a[204:207]
    v_mfma_f32_16x16x16_bf16 a[208:211], a[44:45], v[26:27], a[208:211]
    v_mfma_f32_16x16x16_bf16 a[204:207], a[46:47], v[28:29], a[204:207]
    v_mfma_f32_16x16x16_bf16 a[208:211], a[48:49], v[28:29], a[208:211]
    s_mov_b32 exec_lo, 0x110011
    s_mov_b32 exec_hi, 0x110011
    buffer_store_dwordx4 a[192:195], v10, s[48:51], s64 offen offset:0
    buffer_store_dwordx4 a[196:199], v10, s[48:51], s64 offen offset:256
    buffer_store_dwordx4 a[200:203], v10, s[48:51], s64 offen offset:512
    s_nop 1
    buffer_store_dwordx4 a[204:207], v11, s[48:51], s64 offen offset:1536
    buffer_store_dwordx4 a[208:211], v11, s[48:51], s64 offen offset:1920
    s_mov_b64 exec, -1
    s_branch JOIN1
GATE:
    s_waitcnt lgkmcnt(0)
    v_mfma_f32_16x16x16_bf16 a[192:195], a[0:1], v[20:21], 0
    v_mfma_f32_16x16x16_bf16 a[196:199], a[2:3], v[20:21], 0
    v_mfma_f32_16x16x16_bf16 a[200:203], a[4:5], v[20:21], 0
    v_mfma_f32_16x16x16_bf16 a[192:195], a[6:7], v[22:23], a[192:195]
    v_mfma_f32_16x16x16_bf16 a[196:199], a[8:9], v[22:23], a[196:199]
    v_mfma_f32_16x16x16_bf16 a[200:203], a[10:11], v[22:23], a[200:203]
    v_mfma_f32_16x16x16_bf16 a[192:195], a[12:13], v[24:25], a[192:195]
    v_mfma_f32_16x16x16_bf16 a[196:199], a[14:15], v[24:25], a[196:199]
    v_mfma_f32_16x16x16_bf16 a[200:203], a[16:17], v[24:25], a[200:203]
    v_mfma_f32_16x16x16_bf16 a[192:195], a[18:19], v[26:27], a[192:195]
    v_mfma_f32_16x16x16_bf16 a[196:199], a[20:21], v[26:27], a[196:199]
    v_mfma_f32_16x16x16_bf16 a[200:203], a[22:23], v[26:27], a[200:203]
    v_mfma_f32_16x16x16_bf16 a[192:195], a[24:25], v[28:29], a[192:195]
    v_mfma_f32_16x16x16_bf16 a[196:199], a[26:27], v[28:29], a[196:199]
    v_mfma_f32_16x16x16_bf16 a[200:203], a[28:29], v[28:29], a[200:203]
    s_mov_b32 exec_lo, 0x110011
    s_mov_b32 exec_hi, 0x110011
    s_nop 3
    buffer_store_dwordx4 a[192:195], v10, s[48:51], s64 offen offset:0
    buffer_store_dwordx4 a[196:199], v10, s[48:51], s64 offen offset:256
    buffer_store_dwordx4 a[200:203], v10, s[48:51], s64 offen offset:512
    s_mov_b64 exec, -1
    s_mov_b32 s3, 0x3f803f80
    v_mov_b32 v34, 0
    v_mov_b32 v35, 0
    v_lshlrev_b32 v36, 16, v40
    v_lshlrev_b32 v37, 16, v52
    v_and_b32 v40, s101, v40
    v_and_b32 v52, s101, v52
    v_mul_f32 v36, v36, v37
    v_mul_f32 v40, v40, v52
    v_cvt_pk_bf16_f32 v36, v36, v40
    v_lshlrev_b32 v38, 16, v41
    v_lshlrev_b32 v39, 16, v53
    v_and_b32 v41, s101, v41
    v_and_b32 v53, s101, v53
    v_mul_f32 v38, v38, v39
    v_mul_f32 v41, v41, v53
    v_cvt_pk_bf16_f32 v38, v38, v41
    v_dot2_f32_bf16 v34, v36, s3, v34
    v_dot2_f32_bf16 v35, v38, s3, v35
    v_lshlrev_b32 v36, 16, v42
    v_lshlrev_b32 v37, 16, v54
    v_and_b32 v42, s101, v42
    v_and_b32 v54, s101, v54
    v_mul_f32 v36, v36, v37
    v_mul_f32 v42, v42, v54
    v_cvt_pk_bf16_f32 v36, v36, v42
    v_lshlrev_b32 v38, 16, v43
    v_lshlrev_b32 v39, 16, v55
    v_and_b32 v43, s101, v43
    v_and_b32 v55, s101, v55
    v_mul_f32 v38, v38, v39
    v_mul_f32 v43, v43, v55
    v_cvt_pk_bf16_f32 v38, v38, v43
    v_dot2_f32_bf16 v34, v36, s3, v34
    v_dot2_f32_bf16 v35, v38, s3, v35
    v_lshlrev_b32 v36, 16, v44
    v_lshlrev_b32 v37, 16, v56
    v_and_b32 v44, s101, v44
    v_and_b32 v56, s101, v56
    v_mul_f32 v36, v36, v37
    v_mul_f32 v44, v44, v56
    v_cvt_pk_bf16_f32 v36, v36, v44
    v_lshlrev_b32 v38, 16, v45
    v_lshlrev_b32 v39, 16, v57
    v_and_b32 v45, s101, v45
    v_and_b32 v57, s101, v57
    v_mul_f32 v38, v38, v39
    v_mul_f32 v45, v45, v57
    v_cvt_pk_bf16_f32 v38, v38, v45
    v_dot2_f32_bf16 v34, v36, s3, v34
    v_dot2_f32_bf16 v35, v38, s3, v35
    v_lshlrev_b32 v36, 16, v46
    v_lshlrev_b32 v37, 16, v58
    v_and_b32 v46, s101, v46
    v_and_b32 v58, s101, v58
    v_mul_f32 v36, v36, v37
    v_mul_f32 v46, v46, v58
    v_cvt_pk_bf16_f32 v36, v36, v46
    v_lshlrev_b32 v38, 16, v47
    v_lshlrev_b32 v39, 16, v59
    v_and_b32 v47, s101, v47
    v_and_b32 v59, s101, v59
    v_mul_f32 v38, v38, v39
    v_mul_f32 v47, v47, v59
    v_cvt_pk_bf16_f32 v38, v38, v47
    v_dot2_f32_bf16 v34, v36, s3, v34
    v_dot2_f32_bf16 v35, v38, s3, v35
    v_lshlrev_b32 v36, 16, v48
    v_lshlrev_b32 v37, 16, v60
    v_and_b32 v48, s101, v48
    v_and_b32 v60, s101, v60
    v_mul_f32 v36, v36, v37
    v_mul_f32 v48, v48, v60
    v_cvt_pk_bf16_f32 v36, v36, v48
    v_lshlrev_b32 v38, 16, v49
    v_lshlrev_b32 v39, 16, v61
    v_and_b32 v49, s101, v49
    v_and_b32 v61, s101, v61
    v_mul_f32 v38, v38, v39
    v_mul_f32 v49, v49, v61
    v_cvt_pk_bf16_f32 v38, v38, v49
    v_dot2_f32_bf16 v34, v36, s3, v34
    v_dot2_f32_bf16 v35, v38, s3, v35
    v_lshlrev_b32 v36, 16, v50
    v_lshlrev_b32 v37, 16, v62
    v_and_b32 v50, s101, v50
    v_and_b32 v62, s101, v62
    v_mul_f32 v36, v36, v37
    v_mul_f32 v50, v50, v62
    v_cvt_pk_bf16_f32 v36, v36, v50
    v_lshlrev_b32 v38, 16, v51
    v_lshlrev_b32 v39, 16, v63
    v_and_b32 v51, s101, v51
    v_and_b32 v63, s101, v63
    v_mul_f32 v38, v38, v39
    v_mul_f32 v51, v51, v63
    v_cvt_pk_bf16_f32 v38, v38, v51
    v_dot2_f32_bf16 v34, v36, s3, v34
    v_dot2_f32_bf16 v35, v38, s3, v35
    s_nop 2
    v_add_f32 v34, v34, v35
    s_nop 1
    v_add_f32_dpp v34, v34, v34 quad_perm:[1,0,3,2] row_mask:0xf bank_mask:0xf
    s_nop 1
    v_add_f32_dpp v34, v34, v34 quad_perm:[2,3,0,1] row_mask:0xf bank_mask:0xf
    s_nop 1
    v_add_f32_dpp v34, v34, v34 row_half_mirror row_mask:0xf bank_mask:0xf
    s_nop 1
    v_add_f32_dpp v34, v34, v34 row_mirror row_mask:0xf bank_mask:0xf
    v_mov_b32 v35, v34
    s_nop 1
    v_permlane16_swap_b32 v34, v35
    v_add_f32 v34, v34, v35
    v_cvt_pk_bf16_f32 v34, v34, v34
    v_and_b32 v34, s101, v34
    v_mul_f32 v34, 0xbfb8aa3b, v34
    v_exp_f32 v34, v34
    s_nop 0
    v_add_f32 v34, 1.0, v34
    v_rcp_f32 v34, v34
    v_lshrrev_b32 v38, 5, v1
    v_cvt_pk_bf16_f32 v34, v34, v34
    v_and_b32 v36, s101, v34
    v_sub_f32 v34, 1.0, v36
    v_cvt_pk_bf16_f32 v34, v34, v34
    v_and_b32 v37, s101, v34
    v_lshlrev_b32 v38, 3, v38
    v_add_u32 v38, 101024, v38
    ds_write_b64 v38, v[36:37]
JOIN1:
    s_add_u32 s58, s58, 6144
    buffer_load_dwordx4 v[184:187], v2, s[4:7], s58 offen offset:0 nt
    buffer_load_dwordx4 v[188:191], v2, s[4:7], s58 offen offset:128 nt
    buffer_load_dwordx4 v[192:195], v2, s[4:7], s58 offen offset:256 nt
    buffer_load_dwordx4 v[196:199], v2, s[4:7], s58 offen offset:3072 nt
    buffer_load_dwordx4 v[200:203], v2, s[4:7], s58 offen offset:3200 nt
    buffer_load_dwordx4 v[204:207], v2, s[4:7], s58 offen offset:3328 nt
    s_add_u32 s58, s58, 6144
    buffer_load_dwordx4 v[208:211], v2, s[4:7], s58 offen offset:0 nt
    buffer_load_dwordx4 v[212:215], v2, s[4:7], s58 offen offset:128 nt
    buffer_load_dwordx4 v[216:219], v2, s[4:7], s58 offen offset:256 nt
    buffer_load_dwordx4 v[220:223], v2, s[4:7], s58 offen offset:3072 nt
    buffer_load_dwordx4 v[224:227], v2, s[4:7], s58 offen offset:3200 nt
    buffer_load_dwordx4 v[228:231], v2, s[4:7], s58 offen offset:3328 nt
    s_add_u32 s58, s58, 6144
    buffer_load_dwordx4 v[232:235], v2, s[4:7], s58 offen offset:0 nt
    buffer_load_dwordx4 v[236:239], v2, s[4:7], s58 offen offset:128 nt
    buffer_load_dwordx4 v[240:243], v2, s[4:7], s58 offen offset:256 nt
    buffer_load_dwordx4 v[244:247], v2, s[4:7], s58 offen offset:3072 nt
    buffer_load_dwordx4 v[248:251], v2, s[4:7], s58 offen offset:3200 nt
    buffer_load_dwordx4 v[252:255], v2, s[4:7], s58 offen offset:3328 nt
    s_and_b32 s66, s56, 3
    s_mul_i32 s3, s66, 3
    s_add_u32 s3, s3, 1
    s_lshr_b32 s3, s3, 1
    s_mul_i32 s3, s3, 40960
    s_mul_i32 s64, s55, 245760
    s_lshr_b32 s53, s54, 1
    s_mul_i32 s53, s53, 2560
    s_add_u32 s64, s64, s53
    s_mul_i32 s53, s54, 1280
    s_add_u32 s64, s64, s53
    s_add_u32 s53, s56, s57
    s_lshl_b32 s53, s53, 7
    s_add_u32 s62, s64, s53
    s_add_u32 s61, s62, 245760
    s_add_u32 s62, s62, s3
    s_add_u32 s64, s64, s3
    s_mul_i32 s3, s57, 640
    s_add_u32 s3, s3, 512
    s_add_u32 s64, s64, s3
    s_min_u32 s66, s66, 2
    s_mul_i32 s66, s66, 20480
    s_add_u32 s3, s3, s66
    s_sub_u32 s3, s3, 20480
    s_add_u32 s53, s53, 40960
    s_cmp_ge_u32 s54, 2
    s_cselect_b32 s96, s3, s53
    s_mul_i32 s63, s55, 61440
    s_mul_i32 s3, s54, 10240
    s_add_u32 s63, s63, s3
    s_add_u32 s96, s96, s63
    s_add_u32 s63, s63, s53
    s_sub_u32 s63, s63, 40960
    v_bfe_u32 v3, v1, 3, 1
    v_lshlrev_b32 v4, 1, v15
    v_and_b32 v5, 7, v1
    v_xor_b32 v5, v5, v4
    v_lshlrev_b32 v5, 4, v5
    v_lshl_add_u32 v6, v15, 2, v3
    v_mul_u32_u24 v6, 2560, v6
    v_add_u32 v8, v6, v5
    v_lshl_add_u32 v6, v3, 2, v15
    v_mul_u32_u24 v6, 1280, v6
    v_add_u32 v9, v6, v5
    v_and_b32 v35, 31, v1
    v_lshlrev_b32 v35, 2, v35
    buffer_load_dword v34, v35, s[44:47], 0 offen offset:0 sc1
    s_mul_i32 s3, s57, 768
    s_mul_i32 s97, s55, 18432
    s_mul_i32 s66, s54, 4608
    s_add_u32 s97, s97, s66
    s_mul_i32 s66, s54, 3072
    s_add_u32 s66, s66, 88064
    v_mov_b32 v3, s3
    v_mov_b32 v4, 768
    v_lshlrev_b32 v5, 4, v1
    v_cmp_lt_u32 vcc, 47, v1
    v_add_u32 v33, s66, v5
    s_nop 0
    v_cndmask_b32 v6, v3, v4, vcc
    v_cmp_lt_u32 vcc, 31, v1
    v_add_u32 v30, v5, v6
    v_add_u32 v5, 1792, v5
    v_cndmask_b32 v6, 0, v3, vcc
    v_cmp_lt_u32 vcc, 15, v1
    v_add_u32 v31, v5, v6
    v_add_u32 v5, 1024, v5
    v_cndmask_b32 v6, v3, v4, vcc
    v_add_u32 v32, v5, v6
    s_mov_b32 s58, s59
    buffer_load_dwordx4 a[0:3], v2, s[8:11], s58 offen offset:0 nt
    buffer_load_dwordx4 a[4:7], v2, s[8:11], s58 offen offset:128 nt
    buffer_load_dwordx4 a[8:11], v2, s[8:11], s58 offen offset:256 nt
    buffer_load_dwordx4 a[12:15], v2, s[8:11], s58 offen offset:3072 nt
    buffer_load_dwordx4 a[16:19], v2, s[8:11], s58 offen offset:3200 nt
    buffer_load_dwordx4 a[20:23], v2, s[8:11], s58 offen offset:3328 nt
    s_add_u32 s58, s58, 6144
    buffer_load_dwordx4 a[24:27], v2, s[8:11], s58 offen offset:0 nt
    buffer_load_dwordx4 a[28:31], v2, s[8:11], s58 offen offset:128 nt
    buffer_load_dwordx4 a[32:35], v2, s[8:11], s58 offen offset:256 nt
    buffer_load_dwordx4 a[36:39], v2, s[8:11], s58 offen offset:3072 nt
    buffer_load_dwordx4 a[40:43], v2, s[8:11], s58 offen offset:3200 nt
    buffer_load_dwordx4 a[44:47], v2, s[8:11], s58 offen offset:3328 nt
    buffer_store_byte v19, v14, s[48:51], 0 offen offset:0
    s_waitcnt vmcnt(13)
VER_CHK:
    v_and_b32 v3, 0xff, v34
    v_cmp_ne_u32 vcc, 8, v3
    s_nop 1
    s_cbranch_vccnz VER_RETRY
VER_OK:
    v_readlane_b32 s3, v34, s55
    s_lshl_b32 s60, s60, 3
    v_cmp_eq_u32 vcc, s60, v34
    s_and_b32 s66, s55, 28
    s_nop 0
    s_lshr_b32 s70, vcc_lo, s66
    s_and_b32 s70, s70, 15
    s_cmp_eq_u32 s70, 15
    s_cselect_b32 s70, -1, 0
    s_cmp_eq_u32 s3, s60
    s_cselect_b32 s60, 1, 0
    s_cmp_eq_u32 s60, 0
    s_cbranch_scc1 REPUB
REPUB_OK:
    buffer_load_dwordx4 v[36:39], v30, s[48:51], s97 offen sc1
    buffer_load_dwordx4 v[40:43], v31, s[48:51], s97 offen sc1
    buffer_load_dwordx4 v[44:47], v32, s[48:51], s97 offen sc1
    buffer_load_dword v13, v12, s[48:51], 0 offen offset:0 sc1
    s_add_u32 s58, s58, 6144
    buffer_load_dwordx4 a[48:51], v2, s[8:11], s58 offen offset:0 nt
    buffer_load_dwordx4 a[52:55], v2, s[8:11], s58 offen offset:128 nt
    buffer_load_dwordx4 a[56:59], v2, s[8:11], s58 offen offset:256 nt
    buffer_load_dwordx4 a[60:63], v2, s[8:11], s58 offen offset:3072 nt
    buffer_load_dwordx4 a[64:67], v2, s[8:11], s58 offen offset:3200 nt
    buffer_load_dwordx4 a[68:71], v2, s[8:11], s58 offen offset:3328 nt
    s_add_u32 s58, s58, 6144
    buffer_load_dwordx4 a[72:75], v2, s[8:11], s58 offen offset:0 nt
    buffer_load_dwordx4 a[76:79], v2, s[8:11], s58 offen offset:128 nt
    buffer_load_dwordx4 a[80:83], v2, s[8:11], s58 offen offset:256 nt
    buffer_load_dwordx4 a[84:87], v2, s[8:11], s58 offen offset:3072 nt
    buffer_load_dwordx4 a[88:91], v2, s[8:11], s58 offen offset:3200 nt
    buffer_load_dwordx4 a[92:95], v2, s[8:11], s58 offen offset:3328 nt
    s_waitcnt vmcnt(13)
GA_CHK:
    v_max3_u32 v3, v36, v37, v38
    v_max3_u32 v3, v3, v39, v40
    v_max3_u32 v3, v3, v41, v42
    v_max3_u32 v3, v3, v43, v44
    v_max3_u32 v3, v3, v45, v46
    v_max_u32 v3, v3, v47
    v_cmp_eq_u32 vcc, -1, v3
    s_nop 1
    s_cbranch_vccnz GA_RETRY
GA_OK:
    s_waitcnt vmcnt(12)
    s_mov_b32 s53, 30
FC_LOOP0:
    v_cmp_eq_u32 vcc, 0x01010101, v13
    s_nop 1
    s_bcnt1_i32_b32 s52, vcc_lo
    s_orn2_b32 s52, s52, s70
    s_cmp_lt_u32 s52, 16
    s_cbranch_scc1 FC_RETRY0
FC_OK0:
    buffer_store_byte v19, v14, s[48:51], 0 offen offset:1024
    ds_write_b128 v33, v[36:39] offset:0
    ds_write_b128 v33, v[40:43] offset:1024
    ds_write_b128 v33, v[44:47] offset:2048
    v_lshlrev_b32 v34, 2, v0
    v_lshlrev_b32 v35, 1, v0
    v_add_u32 v34, 88064, v34
    v_add_u32 v35, 100352, v35
    s_waitcnt lgkmcnt(0)
    s_barrier
    s_cmp_eq_u32 s54, 3
    s_cbranch_scc1 HCALC
    ds_read_b32 v36, v34 offset:0
    ds_read_b32 v37, v34 offset:1536
    ds_read_b32 v38, v34 offset:3072
    ds_read_b32 v39, v34 offset:4608
    ds_read_b32 v40, v34 offset:6144
    ds_read_b32 v41, v34 offset:7680
    ds_read_b32 v42, v34 offset:9216
    ds_read_b32 v43, v34 offset:10752
    s_waitcnt lgkmcnt(0)
    v_add_f32 v36, v36, v37
    v_add_f32 v38, v38, v39
    v_add_f32 v40, v40, v41
    v_add_f32 v42, v42, v43
    v_add_f32 v36, v36, v38
    v_add_f32 v40, v40, v42
    v_add_f32 v36, v36, v40
    v_cvt_pk_bf16_f32 v36, v36, v36
    ds_write_b16 v35, v36
    s_branch JOIN2
HCALC:
    v_lshlrev_b32 v3, 3, v1
    v_add_u32 v3, 88832, v3
    ds_read_b64 v[20:21], v3 offset:0
    ds_read_b64 v[36:37], v3 offset:384
    ds_read_b64 v[22:23], v3 offset:1536
    ds_read_b64 v[38:39], v3 offset:1920
    ds_read_b64 v[24:25], v3 offset:3072
    ds_read_b64 v[40:41], v3 offset:3456
    ds_read_b64 v[26:27], v3 offset:4608
    ds_read_b64 v[42:43], v3 offset:4992
    ds_read_b64 v[28:29], v3 offset:6144
    ds_read_b64 v[44:45], v3 offset:6528
    ds_read_b64 v[30:31], v3 offset:7680
    ds_read_b64 v[46:47], v3 offset:8064
    ds_read_b64 v[32:33], v3 offset:9216
    ds_read_b64 v[48:49], v3 offset:9600
    ds_read_b64 v[34:35], v3 offset:10752
    ds_read_b64 v[50:51], v3 offset:11136
    v_lshlrev_b32 v4, 2, v1
    v_add_u32 v4, 100736, v4
    s_waitcnt lgkmcnt(0)
    v_add_f32 v20, v20, v22
    v_add_f32 v21, v21, v23
    v_add_f32 v36, v36, v38
    v_add_f32 v37, v37, v39
    v_add_f32 v24, v24, v26
    v_add_f32 v25, v25, v27
    v_add_f32 v40, v40, v42
    v_add_f32 v41, v41, v43
    v_add_f32 v28, v28, v30
    v_add_f32 v29, v29, v31
    v_add_f32 v44, v44, v46
    v_add_f32 v45, v45, v47
    v_add_f32 v32, v32, v34
    v_add_f32 v33, v33, v35
    v_add_f32 v48, v48, v50
    v_add_f32 v49, v49, v51
    v_add_f32 v20, v20, v24
    v_add_f32 v21, v21, v25
    v_add_f32 v36, v36, v40
    v_add_f32 v37, v37, v41
    v_add_f32 v28, v28, v32
    v_add_f32 v29, v29, v33
    v_add_f32 v44, v44, v48
    v_add_f32 v45, v45, v49
    v_add_f32 v20, v20, v28
    v_add_f32 v21, v21, v29
    v_add_f32 v36, v36, v44
    v_add_f32 v37, v37, v45
    v_cvt_pk_bf16_f32 v20, v20, v21
    v_cvt_pk_bf16_f32 v36, v36, v37
    v_lshlrev_b32 v22, 16, v20
    v_and_b32 v23, s101, v20
    v_mul_f32 v24, 0xbfb8aa3b, v22
    v_mul_f32 v25, 0xbfb8aa3b, v23
    v_exp_f32 v24, v24
    v_exp_f32 v25, v25
    v_lshlrev_b32 v38, 16, v36
    v_add_f32 v24, 1.0, v24
    v_add_f32 v25, 1.0, v25
    v_rcp_f32 v24, v24
    v_rcp_f32 v25, v25
    v_and_b32 v39, s101, v36
    v_mul_f32 v22, v22, v24
    v_mul_f32 v23, v23, v25
    v_cvt_pk_bf16_f32 v20, v22, v23
    v_lshlrev_b32 v22, 16, v20
    v_and_b32 v23, s101, v20
    v_mul_f32 v22, v22, v38
    v_mul_f32 v23, v23, v39
    v_cvt_pk_bf16_f32 v20, v22, v23
    s_mov_b32 exec_lo, 0xffffffff
    s_mov_b32 exec_hi, 0xffff
    ds_write_b32 v4, v20
    s_mov_b64 exec, -1
JOIN2:
    v_and_b32 v3, 7, v1
    v_lshlrev_b32 v3, 4, v3
    v_add_u32 v3, 100352, v3
    v_and_b32 v4, 1, v1
    v_lshlrev_b32 v4, 4, v4
    v_mov_b32 v5, 0xffff
    v_lshlrev_b32 v4, v4, v5
    v_bfe_u32 v5, v1, 1, 2
    s_waitcnt lgkmcnt(0)
    s_barrier
    ds_read_b128 v[48:51], v3 offset:0
    ds_read_b128 v[52:55], v3 offset:128
    ds_read_b128 v[56:59], v3 offset:256
    v_cmp_eq_u32 vcc, 0, v5
    s_nop 1
    v_cndmask_b32 v60, 0, v4, vcc
    v_cmp_eq_u32 vcc, 1, v5
    s_nop 1
    v_cndmask_b32 v61, 0, v4, vcc
    v_cmp_eq_u32 vcc, 2, v5
    s_nop 1
    v_cndmask_b32 v62, 0, v4, vcc
    v_cmp_eq_u32 vcc, 3, v5
    s_nop 1
    v_cndmask_b32 v63, 0, v4, vcc
    s_waitcnt lgkmcnt(0)
    v_dot2_f32_bf16 v20, v64, v48, 0
    v_dot2_f32_bf16 v21, v76, v48, 0
    v_dot2_f32_bf16 v22, v88, v48, 0
    v_dot2_f32_bf16 v23, v100, v48, 0
    v_dot2c_f32_bf16 v20, v65, v49
    v_dot2c_f32_bf16 v21, v77, v49
    v_dot2c_f32_bf16 v22, v89, v49
    v_dot2c_f32_bf16 v23, v101, v49
    v_dot2c_f32_bf16 v20, v66, v50
    v_dot2c_f32_bf16 v21, v78, v50
    v_dot2c_f32_bf16 v22, v90, v50
    v_dot2c_f32_bf16 v23, v102, v50
    v_dot2c_f32_bf16 v20, v67, v51
    v_dot2c_f32_bf16 v21, v79, v51
    v_dot2c_f32_bf16 v22, v91, v51
    v_dot2c_f32_bf16 v23, v103, v51
    s_add_u32 s58, s58, 6144
    buffer_load_dwordx4 a[96:99], v2, s[8:11], s58 offen offset:0 nt
    v_dot2c_f32_bf16 v20, v68, v52
    v_dot2c_f32_bf16 v21, v80, v52
    v_dot2c_f32_bf16 v22, v92, v52
    v_dot2c_f32_bf16 v23, v104, v52
    v_dot2c_f32_bf16 v20, v69, v53
    v_dot2c_f32_bf16 v21, v81, v53
    v_dot2c_f32_bf16 v22, v93, v53
    v_dot2c_f32_bf16 v23, v105, v53
    v_dot2c_f32_bf16 v20, v70, v54
    v_dot2c_f32_bf16 v21, v82, v54
    v_dot2c_f32_bf16 v22, v94, v54
    v_dot2c_f32_bf16 v23, v106, v54
    v_dot2c_f32_bf16 v20, v71, v55
    v_dot2c_f32_bf16 v21, v83, v55
    v_dot2c_f32_bf16 v22, v95, v55
    v_dot2c_f32_bf16 v23, v107, v55
    buffer_load_dwordx4 a[100:103], v2, s[8:11], s58 offen offset:128 nt
    v_dot2c_f32_bf16 v20, v72, v56
    v_dot2c_f32_bf16 v21, v84, v56
    v_dot2c_f32_bf16 v22, v96, v56
    v_dot2c_f32_bf16 v23, v108, v56
    v_dot2c_f32_bf16 v20, v73, v57
    v_dot2c_f32_bf16 v21, v85, v57
    v_dot2c_f32_bf16 v22, v97, v57
    v_dot2c_f32_bf16 v23, v109, v57
    v_dot2c_f32_bf16 v20, v74, v58
    v_dot2c_f32_bf16 v21, v86, v58
    v_dot2c_f32_bf16 v22, v98, v58
    v_dot2c_f32_bf16 v23, v110, v58
    v_dot2c_f32_bf16 v20, v75, v59
    v_dot2c_f32_bf16 v21, v87, v59
    v_dot2c_f32_bf16 v22, v99, v59
    v_dot2c_f32_bf16 v23, v111, v59
    buffer_load_dwordx4 a[104:107], v2, s[8:11], s58 offen offset:256 nt
    v_add_f32_dpp v20, v20, v20 quad_perm:[1,0,3,2] row_mask:0xf bank_mask:0xf
    v_add_f32_dpp v21, v21, v21 quad_perm:[1,0,3,2] row_mask:0xf bank_mask:0xf
    v_add_f32_dpp v22, v22, v22 quad_perm:[1,0,3,2] row_mask:0xf bank_mask:0xf
    v_add_f32_dpp v23, v23, v23 quad_perm:[1,0,3,2] row_mask:0xf bank_mask:0xf
    v_add_f32_dpp v20, v20, v20 quad_perm:[2,3,0,1] row_mask:0xf bank_mask:0xf
    v_add_f32_dpp v21, v21, v21 quad_perm:[2,3,0,1] row_mask:0xf bank_mask:0xf
    v_add_f32_dpp v22, v22, v22 quad_perm:[2,3,0,1] row_mask:0xf bank_mask:0xf
    v_add_f32_dpp v23, v23, v23 quad_perm:[2,3,0,1] row_mask:0xf bank_mask:0xf
    v_add_f32_dpp v20, v20, v20 row_half_mirror row_mask:0xf bank_mask:0xf
    v_add_f32_dpp v21, v21, v21 row_half_mirror row_mask:0xf bank_mask:0xf
    v_add_f32_dpp v22, v22, v22 row_half_mirror row_mask:0xf bank_mask:0xf
    v_add_f32_dpp v23, v23, v23 row_half_mirror row_mask:0xf bank_mask:0xf
    v_dot2_f32_bf16 v24, v112, v48, 0
    v_dot2_f32_bf16 v25, v124, v48, 0
    v_dot2_f32_bf16 v26, v136, v48, 0
    v_dot2_f32_bf16 v27, v148, v48, 0
    v_dot2c_f32_bf16 v24, v113, v49
    v_dot2c_f32_bf16 v25, v125, v49
    v_dot2c_f32_bf16 v26, v137, v49
    v_dot2c_f32_bf16 v27, v149, v49
    v_dot2c_f32_bf16 v24, v114, v50
    v_dot2c_f32_bf16 v25, v126, v50
    v_dot2c_f32_bf16 v26, v138, v50
    v_dot2c_f32_bf16 v27, v150, v50
    v_dot2c_f32_bf16 v24, v115, v51
    v_dot2c_f32_bf16 v25, v127, v51
    v_dot2c_f32_bf16 v26, v139, v51
    v_dot2c_f32_bf16 v27, v151, v51
    buffer_load_dwordx4 a[108:111], v2, s[8:11], s58 offen offset:3072 nt
    v_dot2c_f32_bf16 v24, v116, v52
    v_dot2c_f32_bf16 v25, v128, v52
    v_dot2c_f32_bf16 v26, v140, v52
    v_dot2c_f32_bf16 v27, v152, v52
    v_dot2c_f32_bf16 v24, v117, v53
    v_dot2c_f32_bf16 v25, v129, v53
    v_dot2c_f32_bf16 v26, v141, v53
    v_dot2c_f32_bf16 v27, v153, v53
    v_dot2c_f32_bf16 v24, v118, v54
    v_dot2c_f32_bf16 v25, v130, v54
    v_dot2c_f32_bf16 v26, v142, v54
    v_dot2c_f32_bf16 v27, v154, v54
    v_dot2c_f32_bf16 v24, v119, v55
    v_dot2c_f32_bf16 v25, v131, v55
    v_dot2c_f32_bf16 v26, v143, v55
    v_dot2c_f32_bf16 v27, v155, v55
    buffer_load_dwordx4 a[112:115], v2, s[8:11], s58 offen offset:3200 nt
    v_dot2c_f32_bf16 v24, v120, v56
    v_dot2c_f32_bf16 v25, v132, v56
    v_dot2c_f32_bf16 v26, v144, v56
    v_dot2c_f32_bf16 v27, v156, v56
    v_dot2c_f32_bf16 v24, v121, v57
    v_dot2c_f32_bf16 v25, v133, v57
    v_dot2c_f32_bf16 v26, v145, v57
    v_dot2c_f32_bf16 v27, v157, v57
    v_dot2c_f32_bf16 v24, v122, v58
    v_dot2c_f32_bf16 v25, v134, v58
    v_dot2c_f32_bf16 v26, v146, v58
    v_dot2c_f32_bf16 v27, v158, v58
    v_dot2c_f32_bf16 v24, v123, v59
    v_dot2c_f32_bf16 v25, v135, v59
    v_dot2c_f32_bf16 v26, v147, v59
    v_dot2c_f32_bf16 v27, v159, v59
    buffer_load_dwordx4 a[116:119], v2, s[8:11], s58 offen offset:3328 nt
    v_add_f32_dpp v24, v24, v24 quad_perm:[1,0,3,2] row_mask:0xf bank_mask:0xf
    v_add_f32_dpp v25, v25, v25 quad_perm:[1,0,3,2] row_mask:0xf bank_mask:0xf
    v_add_f32_dpp v26, v26, v26 quad_perm:[1,0,3,2] row_mask:0xf bank_mask:0xf
    v_add_f32_dpp v27, v27, v27 quad_perm:[1,0,3,2] row_mask:0xf bank_mask:0xf
    v_add_f32_dpp v24, v24, v24 quad_perm:[2,3,0,1] row_mask:0xf bank_mask:0xf
    v_add_f32_dpp v25, v25, v25 quad_perm:[2,3,0,1] row_mask:0xf bank_mask:0xf
    v_add_f32_dpp v26, v26, v26 quad_perm:[2,3,0,1] row_mask:0xf bank_mask:0xf
    v_add_f32_dpp v27, v27, v27 quad_perm:[2,3,0,1] row_mask:0xf bank_mask:0xf
    v_add_f32_dpp v24, v24, v24 row_half_mirror row_mask:0xf bank_mask:0xf
    v_add_f32_dpp v25, v25, v25 row_half_mirror row_mask:0xf bank_mask:0xf
    v_add_f32_dpp v26, v26, v26 row_half_mirror row_mask:0xf bank_mask:0xf
    v_add_f32_dpp v27, v27, v27 row_half_mirror row_mask:0xf bank_mask:0xf
    v_dot2_f32_bf16 v28, v160, v48, 0
    v_dot2_f32_bf16 v29, v172, v48, 0
    v_dot2_f32_bf16 v30, v184, v48, 0
    v_dot2_f32_bf16 v31, v196, v48, 0
    v_dot2c_f32_bf16 v28, v161, v49
    v_dot2c_f32_bf16 v29, v173, v49
    v_dot2c_f32_bf16 v30, v185, v49
    v_dot2c_f32_bf16 v31, v197, v49
    v_dot2c_f32_bf16 v28, v162, v50
    v_dot2c_f32_bf16 v29, v174, v50
    v_dot2c_f32_bf16 v30, v186, v50
    v_dot2c_f32_bf16 v31, v198, v50
    v_dot2c_f32_bf16 v28, v163, v51
    v_dot2c_f32_bf16 v29, v175, v51
    v_dot2c_f32_bf16 v30, v187, v51
    v_dot2c_f32_bf16 v31, v199, v51
    buffer_load_dword v13, v12, s[48:51], 0 offen offset:1024 sc1
    s_add_u32 s58, s58, 6144
    buffer_load_dwordx4 a[120:123], v2, s[8:11], s58 offen offset:0 nt
    v_dot2c_f32_bf16 v28, v164, v52
    v_dot2c_f32_bf16 v29, v176, v52
    v_dot2c_f32_bf16 v30, v188, v52
    v_dot2c_f32_bf16 v31, v200, v52
    v_dot2c_f32_bf16 v28, v165, v53
    v_dot2c_f32_bf16 v29, v177, v53
    v_dot2c_f32_bf16 v30, v189, v53
    v_dot2c_f32_bf16 v31, v201, v53
    v_dot2c_f32_bf16 v28, v166, v54
    v_dot2c_f32_bf16 v29, v178, v54
    v_dot2c_f32_bf16 v30, v190, v54
    v_dot2c_f32_bf16 v31, v202, v54
    v_dot2c_f32_bf16 v28, v167, v55
    v_dot2c_f32_bf16 v29, v179, v55
    v_dot2c_f32_bf16 v30, v191, v55
    v_dot2c_f32_bf16 v31, v203, v55
    buffer_load_dwordx4 a[124:127], v2, s[8:11], s58 offen offset:128 nt
    v_dot2c_f32_bf16 v28, v168, v56
    v_dot2c_f32_bf16 v29, v180, v56
    v_dot2c_f32_bf16 v30, v192, v56
    v_dot2c_f32_bf16 v31, v204, v56
    v_dot2c_f32_bf16 v28, v169, v57
    v_dot2c_f32_bf16 v29, v181, v57
    v_dot2c_f32_bf16 v30, v193, v57
    v_dot2c_f32_bf16 v31, v205, v57
    v_dot2c_f32_bf16 v28, v170, v58
    v_dot2c_f32_bf16 v29, v182, v58
    v_dot2c_f32_bf16 v30, v194, v58
    v_dot2c_f32_bf16 v31, v206, v58
    v_dot2c_f32_bf16 v28, v171, v59
    v_dot2c_f32_bf16 v29, v183, v59
    v_dot2c_f32_bf16 v30, v195, v59
    v_dot2c_f32_bf16 v31, v207, v59
    buffer_load_dwordx4 a[128:131], v2, s[8:11], s58 offen offset:256 nt
    v_add_f32_dpp v28, v28, v28 quad_perm:[1,0,3,2] row_mask:0xf bank_mask:0xf
    v_add_f32_dpp v29, v29, v29 quad_perm:[1,0,3,2] row_mask:0xf bank_mask:0xf
    v_add_f32_dpp v30, v30, v30 quad_perm:[1,0,3,2] row_mask:0xf bank_mask:0xf
    v_add_f32_dpp v31, v31, v31 quad_perm:[1,0,3,2] row_mask:0xf bank_mask:0xf
    v_add_f32_dpp v28, v28, v28 quad_perm:[2,3,0,1] row_mask:0xf bank_mask:0xf
    v_add_f32_dpp v29, v29, v29 quad_perm:[2,3,0,1] row_mask:0xf bank_mask:0xf
    v_add_f32_dpp v30, v30, v30 quad_perm:[2,3,0,1] row_mask:0xf bank_mask:0xf
    v_add_f32_dpp v31, v31, v31 quad_perm:[2,3,0,1] row_mask:0xf bank_mask:0xf
    v_add_f32_dpp v28, v28, v28 row_half_mirror row_mask:0xf bank_mask:0xf
    v_add_f32_dpp v29, v29, v29 row_half_mirror row_mask:0xf bank_mask:0xf
    v_add_f32_dpp v30, v30, v30 row_half_mirror row_mask:0xf bank_mask:0xf
    v_add_f32_dpp v31, v31, v31 row_half_mirror row_mask:0xf bank_mask:0xf
    v_dot2_f32_bf16 v32, v208, v48, 0
    v_dot2_f32_bf16 v33, v220, v48, 0
    v_dot2_f32_bf16 v34, v232, v48, 0
    v_dot2_f32_bf16 v35, v244, v48, 0
    v_dot2c_f32_bf16 v32, v209, v49
    v_dot2c_f32_bf16 v33, v221, v49
    v_dot2c_f32_bf16 v34, v233, v49
    v_dot2c_f32_bf16 v35, v245, v49
    v_dot2c_f32_bf16 v32, v210, v50
    v_dot2c_f32_bf16 v33, v222, v50
    v_dot2c_f32_bf16 v34, v234, v50
    v_dot2c_f32_bf16 v35, v246, v50
    v_dot2c_f32_bf16 v32, v211, v51
    v_dot2c_f32_bf16 v33, v223, v51
    v_dot2c_f32_bf16 v34, v235, v51
    v_dot2c_f32_bf16 v35, v247, v51
    buffer_load_dwordx4 a[132:135], v2, s[8:11], s58 offen offset:3072 nt
    v_dot2c_f32_bf16 v32, v212, v52
    v_dot2c_f32_bf16 v33, v224, v52
    v_dot2c_f32_bf16 v34, v236, v52
    v_dot2c_f32_bf16 v35, v248, v52
    v_dot2c_f32_bf16 v32, v213, v53
    v_dot2c_f32_bf16 v33, v225, v53
    v_dot2c_f32_bf16 v34, v237, v53
    v_dot2c_f32_bf16 v35, v249, v53
    v_dot2c_f32_bf16 v32, v214, v54
    v_dot2c_f32_bf16 v33, v226, v54
    v_dot2c_f32_bf16 v34, v238, v54
    v_dot2c_f32_bf16 v35, v250, v54
    v_dot2c_f32_bf16 v32, v215, v55
    v_dot2c_f32_bf16 v33, v227, v55
    v_dot2c_f32_bf16 v34, v239, v55
    v_dot2c_f32_bf16 v35, v251, v55
    buffer_load_dwordx4 a[136:139], v2, s[8:11], s58 offen offset:3200 nt
    v_dot2c_f32_bf16 v32, v216, v56
    v_dot2c_f32_bf16 v33, v228, v56
    v_dot2c_f32_bf16 v34, v240, v56
    v_dot2c_f32_bf16 v35, v252, v56
    v_dot2c_f32_bf16 v32, v217, v57
    v_dot2c_f32_bf16 v33, v229, v57
    v_dot2c_f32_bf16 v34, v241, v57
    v_dot2c_f32_bf16 v35, v253, v57
    v_dot2c_f32_bf16 v32, v218, v58
    v_dot2c_f32_bf16 v33, v230, v58
    v_dot2c_f32_bf16 v34, v242, v58
    v_dot2c_f32_bf16 v35, v254, v58
    v_dot2c_f32_bf16 v32, v219, v59
    v_dot2c_f32_bf16 v33, v231, v59
    v_dot2c_f32_bf16 v34, v243, v59
    v_dot2c_f32_bf16 v35, v255, v59
    buffer_load_dwordx4 a[140:143], v2, s[8:11], s58 offen offset:3328 nt
    v_add_f32_dpp v32, v32, v32 quad_perm:[1,0,3,2] row_mask:0xf bank_mask:0xf
    v_add_f32_dpp v33, v33, v33 quad_perm:[1,0,3,2] row_mask:0xf bank_mask:0xf
    v_add_f32_dpp v34, v34, v34 quad_perm:[1,0,3,2] row_mask:0xf bank_mask:0xf
    v_add_f32_dpp v35, v35, v35 quad_perm:[1,0,3,2] row_mask:0xf bank_mask:0xf
    v_add_f32_dpp v32, v32, v32 quad_perm:[2,3,0,1] row_mask:0xf bank_mask:0xf
    v_add_f32_dpp v33, v33, v33 quad_perm:[2,3,0,1] row_mask:0xf bank_mask:0xf
    v_add_f32_dpp v34, v34, v34 quad_perm:[2,3,0,1] row_mask:0xf bank_mask:0xf
    v_add_f32_dpp v35, v35, v35 quad_perm:[2,3,0,1] row_mask:0xf bank_mask:0xf
    v_add_f32_dpp v32, v32, v32 row_half_mirror row_mask:0xf bank_mask:0xf
    v_add_f32_dpp v33, v33, v33 row_half_mirror row_mask:0xf bank_mask:0xf
    v_add_f32_dpp v34, v34, v34 row_half_mirror row_mask:0xf bank_mask:0xf
    v_add_f32_dpp v35, v35, v35 row_half_mirror row_mask:0xf bank_mask:0xf
    s_mov_b32 s3, 0x3d93cd3a
    v_cvt_pk_bf16_f32 v36, v20, v21
    v_cvt_pk_bf16_f32 v37, v22, v23
    v_cvt_pk_bf16_f32 v38, v24, v25
    v_cvt_pk_bf16_f32 v39, v26, v27
    v_lshlrev_b32 v20, 16, v36
    v_and_b32 v21, s101, v36
    v_lshlrev_b32 v22, 16, v37
    v_and_b32 v23, s101, v37
    v_lshlrev_b32 v24, 16, v38
    v_and_b32 v25, s101, v38
    v_lshlrev_b32 v26, 16, v39
    v_and_b32 v27, s101, v39
    v_mul_f32 v20, s3, v20
    v_mul_f32 v21, s3, v21
    v_mul_f32 v22, s3, v22
    v_mul_f32 v23, s3, v23
    v_mul_f32 v24, s3, v24
    v_mul_f32 v25, s3, v25
    v_mul_f32 v26, s3, v26
    v_mul_f32 v27, s3, v27
    v_cvt_pk_bf16_f32 v36, v20, v21
    v_cvt_pk_bf16_f32 v37, v22, v23
    v_cvt_pk_bf16_f32 v38, v24, v25
    v_cvt_pk_bf16_f32 v39, v26, v27
    v_lshlrev_b32 v20, 16, v36
    v_and_b32 v21, s101, v36
    v_lshlrev_b32 v22, 16, v37
    v_and_b32 v23, s101, v37
    v_lshlrev_b32 v24, 16, v38
    v_and_b32 v25, s101, v38
    v_lshlrev_b32 v26, 16, v39
    v_and_b32 v27, s101, v39
    s_add_u32 s58, s58, 6144
    buffer_load_dwordx4 a[144:147], v2, s[8:11], s58 offen offset:0 nt
    v_cvt_pk_bf16_f32 v36, v28, v29
    v_cvt_pk_bf16_f32 v37, v30, v31
    v_cvt_pk_bf16_f32 v38, v32, v33
    v_cvt_pk_bf16_f32 v39, v34, v35
    v_lshlrev_b32 v28, 16, v36
    v_and_b32 v29, s101, v36
    v_lshlrev_b32 v30, 16, v37
    v_and_b32 v31, s101, v37
    v_lshlrev_b32 v32, 16, v38
    v_and_b32 v33, s101, v38
    v_lshlrev_b32 v34, 16, v39
    v_and_b32 v35, s101, v39
    v_mul_f32 v28, s3, v28
    v_mul_f32 v29, s3, v29
    v_mul_f32 v30, s3, v30
    v_mul_f32 v31, s3, v31
    v_mul_f32 v32, s3, v32
    v_mul_f32 v33, s3, v33
    v_mul_f32 v34, s3, v34
    v_mul_f32 v35, s3, v35
    v_cvt_pk_bf16_f32 v36, v28, v29
    v_cvt_pk_bf16_f32 v37, v30, v31
    v_cvt_pk_bf16_f32 v38, v32, v33
    v_cvt_pk_bf16_f32 v39, v34, v35
    v_lshlrev_b32 v28, 16, v36
    v_and_b32 v29, s101, v36
    v_lshlrev_b32 v30, 16, v37
    v_and_b32 v31, s101, v37
    v_lshlrev_b32 v32, 16, v38
    v_and_b32 v33, s101, v38
    v_lshlrev_b32 v34, 16, v39
    v_and_b32 v35, s101, v39
    buffer_load_dwordx4 a[148:151], v2, s[8:11], s58 offen offset:128 nt
    v_max3_f32 v3, v20, v21, v22
    v_max3_f32 v4, v23, v24, v25
    v_max3_f32 v5, v26, v27, v28
    v_max3_f32 v3, v3, v29, v30
    v_max3_f32 v4, v4, v31, v32
    v_max3_f32 v5, v5, v33, v34
    v_max3_f32 v3, v3, v4, v35
    v_max_f32 v3, v3, v5
    s_lshl_b32 s3, s54, 2
    v_mov_b32 v5, s3
    v_max_f32_dpp v3, v3, v3 row_ror:8 row_mask:0xf bank_mask:0xf
    v_mov_b32 v4, v3
    s_nop 1
    v_permlane16_swap_b32 v3, v4
    v_max_f32 v3, v3, v4
    v_mov_b32 v4, v3
    s_nop 1
    v_permlane32_swap_b32 v3, v4
    v_max_f32 v3, v3, v4
    v_add_u32 v5, 100992, v5
    ds_write_b32 v5, v3
    v_mov_b32 v6, 100992
    s_waitcnt lgkmcnt(0)
    s_barrier
    ds_read_b128 v[36:39], v6
    buffer_load_dwordx4 a[152:155], v2, s[8:11], s58 offen offset:256 nt
    s_mov_b32 s3, 0x3fb8aa3b
    s_waitcnt lgkmcnt(0)
    v_max3_f32 v36, v36, v37, v38
    v_max_f32 v36, v36, v39
    v_mul_f32 v50, s3, v36
    v_fma_f32 v20, v20, s3, -v50
    v_fma_f32 v21, v21, s3, -v50
    v_fma_f32 v22, v22, s3, -v50
    v_fma_f32 v23, v23, s3, -v50
    v_fma_f32 v24, v24, s3, -v50
    v_fma_f32 v25, v25, s3, -v50
    v_fma_f32 v26, v26, s3, -v50
    v_fma_f32 v27, v27, s3, -v50
    v_fma_f32 v28, v28, s3, -v50
    v_fma_f32 v29, v29, s3, -v50
    v_fma_f32 v30, v30, s3, -v50
    v_fma_f32 v31, v31, s3, -v50
    v_fma_f32 v32, v32, s3, -v50
    v_fma_f32 v33, v33, s3, -v50
    v_fma_f32 v34, v34, s3, -v50
    v_fma_f32 v35, v35, s3, -v50
    v_exp_f32 v20, v20
    v_exp_f32 v21, v21
    v_exp_f32 v22, v22
    v_exp_f32 v23, v23
    v_exp_f32 v24, v24
    v_exp_f32 v25, v25
    v_exp_f32 v26, v26
    v_exp_f32 v27, v27
    v_exp_f32 v28, v28
    v_exp_f32 v29, v29
    v_exp_f32 v30, v30
    v_exp_f32 v31, v31
    v_exp_f32 v32, v32
    v_exp_f32 v33, v33
    v_exp_f32 v34, v34
    v_exp_f32 v35, v35
    buffer_load_dwordx4 a[156:159], v2, s[8:11], s58 offen offset:3072 nt
    v_cvt_pk_bf16_f32 v36, v20, v20
    v_cvt_pk_bf16_f32 v37, v21, v21
    v_cvt_pk_bf16_f32 v38, v22, v22
    v_cvt_pk_bf16_f32 v39, v23, v23
    v_and_b32 v64, v36, v60
    v_and_b32 v65, v36, v61
    v_and_b32 v66, v36, v62
    v_and_b32 v67, v36, v63
    v_and_b32 v68, v37, v60
    v_and_b32 v69, v37, v61
    v_and_b32 v70, v37, v62
    v_and_b32 v71, v37, v63
    v_and_b32 v72, v38, v60
    v_and_b32 v73, v38, v61
    v_and_b32 v74, v38, v62
    v_and_b32 v75, v38, v63
    v_and_b32 v76, v39, v60
    v_and_b32 v77, v39, v61
    v_and_b32 v78, v39, v62
    v_and_b32 v79, v39, v63
    buffer_load_dwordx4 a[160:163], v2, s[8:11], s58 offen offset:3200 nt
    v_cvt_pk_bf16_f32 v36, v24, v24
    v_cvt_pk_bf16_f32 v37, v25, v25
    v_cvt_pk_bf16_f32 v38, v26, v26
    v_cvt_pk_bf16_f32 v39, v27, v27
    v_and_b32 v80, v36, v60
    v_and_b32 v81, v36, v61
    v_and_b32 v82, v36, v62
    v_and_b32 v83, v36, v63
    v_and_b32 v84, v37, v60
    v_and_b32 v85, v37, v61
    v_and_b32 v86, v37, v62
    v_and_b32 v87, v37, v63
    v_and_b32 v88, v38, v60
    v_and_b32 v89, v38, v61
    v_and_b32 v90, v38, v62
    v_and_b32 v91, v38, v63
    v_and_b32 v92, v39, v60
    v_and_b32 v93, v39, v61
    v_and_b32 v94, v39, v62
    v_and_b32 v95, v39, v63
    buffer_load_dwordx4 a[164:167], v2, s[8:11], s58 offen offset:3328 nt
    v_cvt_pk_bf16_f32 v36, v28, v28
    v_cvt_pk_bf16_f32 v37, v29, v29
    v_cvt_pk_bf16_f32 v38, v30, v30
    v_cvt_pk_bf16_f32 v39, v31, v31
    v_and_b32 v96, v36, v60
    v_and_b32 v97, v36, v61
    v_and_b32 v98, v36, v62
    v_and_b32 v99, v36, v63
    v_and_b32 v100, v37, v60
    v_and_b32 v101, v37, v61
    v_and_b32 v102, v37, v62
    v_and_b32 v103, v37, v63
    v_and_b32 v104, v38, v60
    v_and_b32 v105, v38, v61
    v_and_b32 v106, v38, v62
    v_and_b32 v107, v38, v63
    v_and_b32 v108, v39, v60
    v_and_b32 v109, v39, v61
    v_and_b32 v110, v39, v62
    v_and_b32 v111, v39, v63
    s_add_u32 s58, s58, 6144
    buffer_load_dwordx4 a[168:171], v2, s[8:11], s58 offen offset:0 nt
    v_cvt_pk_bf16_f32 v36, v32, v32
    v_cvt_pk_bf16_f32 v37, v33, v33
    v_cvt_pk_bf16_f32 v38, v34, v34
    v_cvt_pk_bf16_f32 v39, v35, v35
    v_and_b32 v112, v36, v60
    v_and_b32 v113, v36, v61
    v_and_b32 v114, v36, v62
    v_and_b32 v115, v36, v63
    v_and_b32 v116, v37, v60
    v_and_b32 v117, v37, v61
    v_and_b32 v118, v37, v62
    v_and_b32 v119, v37, v63
    v_and_b32 v120, v38, v60
    v_and_b32 v121, v38, v61
    v_and_b32 v122, v38, v62
    v_and_b32 v123, v38, v63
    v_and_b32 v124, v39, v60
    v_and_b32 v125, v39, v61
    v_and_b32 v126, v39, v62
    v_and_b32 v127, v39, v63
    buffer_load_dwordx4 a[172:175], v2, s[8:11], s58 offen offset:128 nt
    v_add_f32 v20, v20, v28
    v_add_f32 v21, v21, v29
    v_add_f32 v22, v22, v30
    v_add_f32 v23, v23, v31
    v_add_f32 v24, v24, v32
    v_add_f32 v25, v25, v33
    v_add_f32 v26, v26, v34
    v_add_f32 v27, v27, v35
    v_add_f32 v20, v20, v24
    v_add_f32 v21, v21, v25
    v_add_f32 v22, v22, v26
    v_add_f32 v23, v23, v27
    v_add_f32 v20, v20, v22
    v_add_f32 v21, v21, v23
    v_add_f32 v20, v20, v21
    v_add_u32 v5, 16, v5
    s_nop 0
    v_add_f32_dpp v20, v20, v20 row_ror:8 row_mask:0xf bank_mask:0xf
    v_mov_b32 v4, v20
    s_nop 1
    v_permlane16_swap_b32 v20, v4
    v_add_f32 v20, v20, v4
    v_mov_b32 v4, v20
    s_nop 1
    v_permlane32_swap_b32 v20, v4
    v_add_f32 v20, v20, v4
    ds_write_b32 v5, v20
    buffer_load_dwordx4 a[176:179], v2, s[8:11], s58 offen offset:256 nt
    v_lshrrev_b32 v3, 5, v1
    v_bfe_u32 v4, v1, 2, 2
    v_and_b32 v5, 1, v15
    v_xor_b32 v6, s54, v4
    v_lshl_add_u32 v4, v4, 1, v5
    v_lshlrev_b32 v6, 5, v6
    v_lshl_add_u32 v4, v4, 7, v6
    v_lshl_add_u32 v4, v18, 3, v4
    v_add_u32 v4, 47104, v4
    v_lshl_add_u32 v22, v3, 11, v4
    v_lshl_add_u32 v23, v3, 10, v4
    s_and_b32 s3, s56, 3
    s_min_u32 s66, s3, 2
    s_lshl_b32 s66, s66, 5
    s_cmp_eq_u32 s3, 3
    s_cselect_b32 s59, 0, 0.25
    v_mov_b32 v32, s59
    s_mul_i32 s3, s3, 3
    s_add_u32 s3, s3, 1
    s_lshr_b32 s3, s3, 1
    v_mov_b32 v31, s66
    s_cmp_eq_u32 s54, 3
    s_cselect_b32 s3, 0, s3
    s_cselect_b32 s57, 63, 5
    s_cselect_b32 s97, 0, 63
    s_cselect_b32 s66, 0, 7
    v_and_b32 v34, s66, v1
    s_lshl_b32 s66, s54, 1
    s_add_u32 s3, s3, s66
    v_lshrrev_b32 v25, 2, v34
    v_and_b32 v34, 3, v34
    v_add_u32 v25, s3, v25
    v_cmp_lt_u32 vcc, s57, v25
    v_subrev_u32 v26, 6, v25
    v_lshrrev_b32 v33, 3, v1
    v_cndmask_b32 v25, v25, v26, vcc
    v_lshlrev_b32 v25, 6, v25
    v_lshl_add_u32 v25, v34, 4, v25
    v_lshl_add_u32 v25, v33, 9, v25
    s_lshl_b32 s66, s54, 7
    s_add_u32 s66, s66, 88064
    v_mul_u32_u24 v26, 400, v33
    v_add_u32 v26, s66, v26
    v_lshlrev_b32 v33, 4, v1
    v_add_u32 v33, 91264, v33
    v_mul_u32_u24 v4, 96, v16
    v_lshl_add_u32 v4, v15, 3, v4
    v_add_u32 v24, 100736, v4
    v_and_b32 v6, 7, v1
    v_add_u32 v31, v31, v24
    v_lshl_add_u32 v26, v6, 4, v26
    v_cmp_lt_u32 vcc, s97, v6
    v_mul_u32_u24 v34, 400, v6
    s_nop 0
    v_cndmask_b32 v26, v26, v33, vcc
    v_add_u32 v34, 88064, v34
    v_lshl_add_u32 v33, v15, 4, v34
    s_mul_i32 s3, s54, 1600
    s_add_u32 s3, s3, 101120
    v_mul_u32_u24 v4, 800, v3
    v_lshl_add_u32 v4, v5, 7, v4
    v_lshl_add_u32 v4, v6, 4, v4
    v_add_u32 v27, s3, v4
    s_lshl_b32 s3, s54, 8
    s_add_u32 s3, s3, 101120
    v_mul_u32_u24 v4, 1600, v18
    v_lshl_add_u32 v4, v17, 4, v4
    v_add_u32 v28, s3, v4
    v_lshlrev_b32 v4, 5, v15
    v_lshl_add_u32 v29, v16, 4, v4
    s_lshl_b32 s3, s54, 7
    s_lshl_b32 s66, s56, 9
    s_add_u32 s3, s3, s66
    v_lshrrev_b32 v4, 3, v1
    v_lshlrev_b32 v4, 4, v4
    v_add_u32 v30, s3, v4
    s_lshl_b32 s3, s54, 12
    s_add_u32 s98, s98, s3
    s_lshl_b32 s3, s3, 2
    s_add_u32 s99, s99, s3
    v_lshlrev_b32 v4, 3, v16
    v_add_u32 v4, 101024, v4
    ds_read_b64 v[48:49], v4
    buffer_load_dwordx4 a[180:183], v2, s[8:11], s58 offen offset:3072 nt
    s_waitcnt lgkmcnt(0)
    v_mul_f32 v7, 0.25, v49
    v_mul_f32 v32, v32, v49
    s_waitcnt vmcnt(16)
    s_mov_b32 s53, 30
FC_LOOP1:
    v_cmp_eq_u32 vcc, 0x01010101, v13
    s_nop 1
    s_bcnt1_i32_b32 s52, vcc_lo
    s_orn2_b32 s52, s52, s70
    s_cmp_lt_u32 s52, 28
    s_cbranch_scc1 FC_RETRY1
FC_OK1:
    v_mfma_f32_16x16x32_bf16 v[36:39], a[0:3], v[64:67], 0
    v_mfma_f32_16x16x32_bf16 v[40:43], a[4:7], v[64:67], 0
    v_mfma_f32_16x16x32_bf16 v[44:47], a[8:11], v[64:67], 0
    v_mfma_f32_16x16x32_bf16 v[36:39], a[12:15], v[68:71], v[36:39]
    v_mfma_f32_16x16x32_bf16 v[40:43], a[16:19], v[68:71], v[40:43]
    v_mfma_f32_16x16x32_bf16 v[44:47], a[20:23], v[68:71], v[44:47]
    v_mfma_f32_16x16x32_bf16 v[36:39], a[24:27], v[72:75], v[36:39]
    v_mfma_f32_16x16x32_bf16 v[40:43], a[28:31], v[72:75], v[40:43]
    v_mfma_f32_16x16x32_bf16 v[44:47], a[32:35], v[72:75], v[44:47]
    v_mfma_f32_16x16x32_bf16 v[36:39], a[36:39], v[76:79], v[36:39]
    v_mfma_f32_16x16x32_bf16 v[40:43], a[40:43], v[76:79], v[40:43]
    v_mfma_f32_16x16x32_bf16 v[44:47], a[44:47], v[76:79], v[44:47]
    v_mfma_f32_16x16x32_bf16 v[36:39], a[48:51], v[80:83], v[36:39]
    v_mfma_f32_16x16x32_bf16 v[40:43], a[52:55], v[80:83], v[40:43]
    v_mfma_f32_16x16x32_bf16 v[44:47], a[56:59], v[80:83], v[44:47]
    v_mfma_f32_16x16x32_bf16 v[36:39], a[60:63], v[84:87], v[36:39]
    v_mfma_f32_16x16x32_bf16 v[40:43], a[64:67], v[84:87], v[40:43]
    v_mfma_f32_16x16x32_bf16 v[44:47], a[68:71], v[84:87], v[44:47]
    v_mfma_f32_16x16x32_bf16 v[36:39], a[72:75], v[88:91], v[36:39]
    v_mfma_f32_16x16x32_bf16 v[40:43], a[76:79], v[88:91], v[40:43]
    v_mfma_f32_16x16x32_bf16 v[44:47], a[80:83], v[88:91], v[44:47]
    v_mfma_f32_16x16x32_bf16 v[36:39], a[84:87], v[92:95], v[36:39]
    v_mfma_f32_16x16x32_bf16 v[40:43], a[88:91], v[92:95], v[40:43]
    v_mfma_f32_16x16x32_bf16 v[44:47], a[92:95], v[92:95], v[44:47]
    v_mfma_f32_16x16x32_bf16 v[36:39], a[96:99], v[96:99], v[36:39]
    v_mfma_f32_16x16x32_bf16 v[40:43], a[100:103], v[96:99], v[40:43]
    v_mfma_f32_16x16x32_bf16 v[44:47], a[104:107], v[96:99], v[44:47]
    v_mfma_f32_16x16x32_bf16 v[36:39], a[108:111], v[100:103], v[36:39]
    v_mfma_f32_16x16x32_bf16 v[40:43], a[112:115], v[100:103], v[40:43]
    v_mfma_f32_16x16x32_bf16 v[44:47], a[116:119], v[100:103], v[44:47]
    s_waitcnt vmcnt(13)
    v_mfma_f32_16x16x32_bf16 v[36:39], a[120:123], v[104:107], v[36:39]
    v_mfma_f32_16x16x32_bf16 v[40:43], a[124:127], v[104:107], v[40:43]
    v_mfma_f32_16x16x32_bf16 v[44:47], a[128:131], v[104:107], v[44:47]
    buffer_load_dwordx4 a[184:187], v2, s[8:11], s58 offen offset:3200 nt
    buffer_load_dwordx4 a[188:191], v2, s[8:11], s58 offen offset:3328 nt
    s_waitcnt vmcnt(12)
    v_mfma_f32_16x16x32_bf16 v[36:39], a[132:135], v[108:111], v[36:39]
    v_mfma_f32_16x16x32_bf16 v[40:43], a[136:139], v[108:111], v[40:43]
    v_mfma_f32_16x16x32_bf16 v[44:47], a[140:143], v[108:111], v[44:47]
    s_add_u32 m0, s100, 79872
    s_nop 0
    buffer_load_dwordx4 v9, s[28:31], s63 offen nt lds
    s_add_u32 m0, s100, 83968
    s_nop 0
    buffer_load_dwordx4 v9, s[28:31], s96 offen nt lds
    s_add_u32 m0, s100, 47104
    s_nop 0
    buffer_load_dwordx4 v8, s[16:19], s62 offen nt lds
    s_waitcnt vmcnt(12)
    v_mfma_f32_16x16x32_bf16 v[36:39], a[144:147], v[112:115], v[36:39]
    v_mfma_f32_16x16x32_bf16 v[40:43], a[148:151], v[112:115], v[40:43]
    v_mfma_f32_16x16x32_bf16 v[44:47], a[152:155], v[112:115], v[44:47]
    s_add_u32 m0, s100, 51200
    s_add_u32 s62, s62, 40960
    s_cmp_ge_u32 s62, s61
    s_cselect_b32 s53, 245760, 0
    s_sub_u32 s62, s62, s53
    buffer_load_dwordx4 v8, s[16:19], s62 offen nt lds
    s_add_u32 m0, s100, 55296
    s_add_u32 s62, s62, 40960
    s_cmp_ge_u32 s62, s61
    s_cselect_b32 s53, 245760, 0
    s_sub_u32 s62, s62, s53
    buffer_load_dwordx4 v8, s[16:19], s62 offen nt lds
    s_add_u32 m0, s100, 59392
    s_add_u32 s62, s62, 40960
    s_cmp_ge_u32 s62, s61
    s_cselect_b32 s53, 245760, 0
    s_sub_u32 s62, s62, s53
    buffer_load_dwordx4 v8, s[16:19], s62 offen nt lds
    s_waitcnt vmcnt(12)
    v_mfma_f32_16x16x32_bf16 v[36:39], a[156:159], v[116:119], v[36:39]
    v_mfma_f32_16x16x32_bf16 v[40:43], a[160:163], v[116:119], v[40:43]
    v_mfma_f32_16x16x32_bf16 v[44:47], a[164:167], v[116:119], v[44:47]
    s_add_u32 m0, s100, 63488
    s_add_u32 s62, s62, 40960
    s_cmp_ge_u32 s62, s61
    s_cselect_b32 s53, 245760, 0
    s_sub_u32 s62, s62, s53
    buffer_load_dwordx4 v8, s[16:19], s62 offen nt lds
    s_add_u32 m0, s100, 67584
    s_add_u32 s62, s62, 40960
    s_cmp_ge_u32 s62, s61
    s_cselect_b32 s53, 245760, 0
    s_sub_u32 s62, s62, s53
    buffer_load_dwordx4 v8, s[16:19], s62 offen nt lds
    s_add_u32 m0, s100, 71680
    s_nop 0
    buffer_load_dwordx4 v8, s[16:19], s64 offen nt lds
    s_waitcnt vmcnt(12)
    v_mfma_f32_16x16x32_bf16 v[36:39], a[168:171], v[120:123], v[36:39]
    v_mfma_f32_16x16x32_bf16 v[40:43], a[172:175], v[120:123], v[40:43]
    v_mfma_f32_16x16x32_bf16 v[44:47], a[176:179], v[120:123], v[44:47]
    s_add_u32 m0, s100, 75776
    s_add_u32 s64, s64, 40960
    s_bitcmp1_b32 s56, 0
    s_cbranch_scc1 SKIP_WO7
    buffer_load_dwordx4 v8, s[16:19], s64 offen nt lds
SKIP_WO7:
    s_waitcnt vmcnt(11)
    v_mfma_f32_16x16x32_bf16 v[36:39], a[180:183], v[124:127], v[36:39]
    s_waitcnt vmcnt(10)
    v_mfma_f32_16x16x32_bf16 v[40:43], a[184:187], v[124:127], v[40:43]
    s_waitcnt vmcnt(9)
    v_mfma_f32_16x16x32_bf16 v[44:47], a[188:191], v[124:127], v[44:47]
    s_mov_b32 exec_lo, 0xff00ff
    s_mov_b32 exec_hi, 0xff00ff00
    s_nop 1
    ds_write_b128 v27, v[36:39] offset:0
    s_nop 0
    ds_write_b128 v27, v[40:43] offset:256
    s_nop 0
    ds_write_b128 v27, v[44:47] offset:512
    s_mov_b64 exec, -1
    v_mov_b32 v6, 101008
    s_waitcnt vmcnt(7)
    s_waitcnt lgkmcnt(0)
    s_barrier
    s_cmp_eq_u32 s54, 3
    s_cbranch_scc1 MLPUB
    ds_read_b128 v[36:39], v28
    ds_read_b128 v[40:43], v28 offset:800
    s_waitcnt lgkmcnt(0)
    v_add_f32 v36, v36, v40
    v_add_f32 v37, v37, v41
    v_add_f32 v38, v38, v42
    v_add_f32 v39, v39, v43
    v_add_f32_dpp v36, v36, v36 quad_perm:[1,0,3,2] row_mask:0xf bank_mask:0xf
    v_add_f32_dpp v37, v37, v37 quad_perm:[1,0,3,2] row_mask:0xf bank_mask:0xf
    v_add_f32_dpp v38, v38, v38 quad_perm:[1,0,3,2] row_mask:0xf bank_mask:0xf
    v_add_f32_dpp v39, v39, v39 quad_perm:[1,0,3,2] row_mask:0xf bank_mask:0xf
    v_add_f32_dpp v36, v36, v36 quad_perm:[2,3,0,1] row_mask:0xf bank_mask:0xf
    v_add_f32_dpp v37, v37, v37 quad_perm:[2,3,0,1] row_mask:0xf bank_mask:0xf
    v_add_f32_dpp v38, v38, v38 quad_perm:[2,3,0,1] row_mask:0xf bank_mask:0xf
    v_add_f32_dpp v39, v39, v39 quad_perm:[2,3,0,1] row_mask:0xf bank_mask:0xf
    v_cvt_pk_bf16_f32 v40, v36, v37
    v_cvt_pk_bf16_f32 v41, v38, v39
    s_nop 0
    v_mov_b32_dpp v42, v40 row_half_mirror row_mask:0xf bank_mask:0xf
    v_mov_b32_dpp v43, v41 row_half_mirror row_mask:0xf bank_mask:0xf
    s_mov_b32 exec_lo, 0x1010101
    s_mov_b32 exec_hi, 0x1010101
    s_cmp_eq_u32 s60, 0
    s_cbranch_scc1 H1_FAR
    buffer_store_dwordx4 v[40:43], v30, s[48:51], s65 offen
    s_branch JOIN3
MLPUB:
    ds_read_b128 v[36:39], v6
    s_lshl_b32 s3, s56, 9
    s_add_u32 s3, s3, s65
    s_waitcnt lgkmcnt(0)
    v_add_f32 v36, v36, v37
    v_add_f32 v38, v38, v39
    v_mov_b32 v40, v50
    v_add_f32 v41, v36, v38
    v_mov_b32 v42, 0
    v_mov_b32 v43, 0
    s_mov_b32 exec_lo, 0x1
    s_mov_b32 exec_hi, 0x0
    s_cmp_eq_u32 s60, 0
    s_cbranch_scc1 ML_FAR
    buffer_store_dwordx4 v[40:43], off, s[48:51], s3 offset:384
JOIN3:
    s_mov_b64 exec, -1
    ds_read_b64 v[188:189], v24 offset:0
    ds_read_b64_tr_b16 v[176:177], v23 offset:32768
    ds_read_b64 v[190:191], v24 offset:32
    ds_read_b64_tr_b16 v[178:179], v23 offset:34816
    ds_read_b64 v[192:193], v24 offset:64
    ds_read_b64_tr_b16 v[180:181], v23 offset:36864
    ds_read_b64 v[194:195], v31
    ds_read_b64_tr_b16 v[182:183], v23 offset:38912
    s_waitcnt lgkmcnt(0)
    v_mfma_f32_16x16x16_bf16 v[196:199], v[176:177], v[188:189], 0
    v_mfma_f32_16x16x16_bf16 v[200:203], v[182:183], v[194:195], 0
    v_mfma_f32_16x16x16_bf16 v[196:199], v[178:179], v[190:191], v[196:199]
    v_mfma_f32_16x16x16_bf16 v[196:199], v[180:181], v[192:193], v[196:199]
    s_nop 5
    v_mul_f32 v200, v32, v200
    v_mul_f32 v201, v32, v201
    v_mul_f32 v202, v32, v202
    v_mul_f32 v203, v32, v203
    v_mul_f32 v196, v7, v196
    v_mul_f32 v197, v7, v197
    v_mul_f32 v198, v7, v198
    v_mul_f32 v199, v7, v199
    s_waitcnt vmcnt(4)
    s_barrier
    ds_read_b64_tr_b16 v[128:129], v22 offset:0
    ds_read_b64_tr_b16 v[130:131], v22 offset:1024
    ds_read_b64_tr_b16 v[132:133], v22 offset:4096
    ds_read_b64_tr_b16 v[134:135], v22 offset:5120
    ds_read_b64_tr_b16 v[136:137], v22 offset:8192
    ds_read_b64_tr_b16 v[138:139], v22 offset:9216
    ds_read_b64_tr_b16 v[140:141], v22 offset:12288
    ds_read_b64_tr_b16 v[142:143], v22 offset:13312
    buffer_load_dwordx4 v[44:47], v25, s[48:51], s65 offen sc1
    s_waitcnt vmcnt(2)
    s_barrier
    ds_read_b64_tr_b16 v[144:145], v22 offset:16384
    ds_read_b64_tr_b16 v[146:147], v22 offset:17408
    ds_read_b64_tr_b16 v[148:149], v22 offset:20480
    ds_read_b64_tr_b16 v[150:151], v22 offset:21504
    ds_read_b64_tr_b16 v[152:153], v22 offset:24576
    ds_read_b64_tr_b16 v[154:155], v22 offset:25600
    v_mov_b32 v156, 0
    v_mov_b32 v157, 0
    v_mov_b32 v158, 0
    v_mov_b32 v159, 0
    s_bitcmp1_b32 s56, 0
    s_cbranch_scc1 SKIP_FR7
    ds_read_b64_tr_b16 v[156:157], v22 offset:28672
    ds_read_b64_tr_b16 v[158:159], v22 offset:29696
SKIP_FR7:
    s_waitcnt lgkmcnt(0)
P1_WAIT:
    s_waitcnt vmcnt(0)
    v_max3_u32 v3, v44, v45, v46
    v_max_u32 v3, v3, v47
    v_cmp_eq_u32 vcc, -1, v3
    s_nop 1
    s_cbranch_vccnz P1_RETRY
P1_OK:
    ds_write_b128 v26, v[44:47]
    s_waitcnt lgkmcnt(0)
    s_barrier
    ds_read_b64 v[228:229], v34 offset:384
    ds_read_b128 v[204:207], v33 offset:0
    ds_read_b128 v[208:211], v33 offset:64
    ds_read_b128 v[212:215], v33 offset:128
    ds_read_b128 v[216:219], v33 offset:192
    ds_read_b128 v[220:223], v33 offset:256
    ds_read_b128 v[224:227], v33 offset:320
    s_waitcnt lgkmcnt(5)
    v_mfma_f32_16x16x32_bf16 v[232:235], v[128:131], v[204:207], 0
    v_mfma_f32_16x16x32_bf16 v[236:239], v[152:155], v[204:207], 0
    v_max_f32_dpp v20, v228, v228 quad_perm:[1,0,3,2] row_mask:0xf bank_mask:0xf
    s_waitcnt lgkmcnt(4)
    v_mfma_f32_16x16x32_bf16 v[232:235], v[132:135], v[208:211], v[232:235]
    v_mfma_f32_16x16x32_bf16 v[236:239], v[156:159], v[208:211], v[236:239]
    v_max_f32_dpp v20, v20, v20 quad_perm:[2,3,0,1] row_mask:0xf bank_mask:0xf
    s_waitcnt lgkmcnt(3)
    v_mfma_f32_16x16x32_bf16 v[232:235], v[136:139], v[212:215], v[232:235]
    v_sub_f32 v20, v228, v20
    v_exp_f32 v20, v20
    s_waitcnt lgkmcnt(2)
    v_mfma_f32_16x16x32_bf16 v[232:235], v[140:143], v[216:219], v[232:235]
    v_mul_f32 v21, v20, v229
    v_mul_f32 v20, v20, v48
    s_waitcnt lgkmcnt(1)
    v_mfma_f32_16x16x32_bf16 v[232:235], v[144:147], v[220:223], v[232:235]
    v_add_f32_dpp v21, v21, v21 quad_perm:[1,0,3,2] row_mask:0xf bank_mask:0xf
    s_waitcnt lgkmcnt(0)
    v_mfma_f32_16x16x32_bf16 v[232:235], v[148:151], v[224:227], v[232:235]
    v_add_f32_dpp v21, v21, v21 quad_perm:[2,3,0,1] row_mask:0xf bank_mask:0xf
    v_rcp_f32 v21, v21
    s_nop 0
    v_mul_f32 v20, v20, v21
    v_fma_f32 v236, v236, v20, v200
    v_fma_f32 v237, v237, v20, v201
    v_fma_f32 v238, v238, v20, v202
    v_fma_f32 v239, v239, v20, v203
    v_fma_f32 v232, v232, v20, v196
    v_fma_f32 v233, v233, v20, v197
    v_fma_f32 v234, v234, v20, v198
    v_fma_f32 v235, v235, v20, v199
    v_add_f32_dpp v236, v236, v236 quad_perm:[1,0,3,2] row_mask:0xf bank_mask:0xf
    v_add_f32_dpp v237, v237, v237 quad_perm:[1,0,3,2] row_mask:0xf bank_mask:0xf
    v_add_f32_dpp v238, v238, v238 quad_perm:[1,0,3,2] row_mask:0xf bank_mask:0xf
    v_add_f32_dpp v239, v239, v239 quad_perm:[1,0,3,2] row_mask:0xf bank_mask:0xf
    v_add_f32_dpp v232, v232, v232 quad_perm:[1,0,3,2] row_mask:0xf bank_mask:0xf
    v_add_f32_dpp v233, v233, v233 quad_perm:[1,0,3,2] row_mask:0xf bank_mask:0xf
    v_add_f32_dpp v234, v234, v234 quad_perm:[1,0,3,2] row_mask:0xf bank_mask:0xf
    v_add_f32_dpp v235, v235, v235 quad_perm:[1,0,3,2] row_mask:0xf bank_mask:0xf
    v_add_f32_dpp v236, v236, v236 quad_perm:[2,3,0,1] row_mask:0xf bank_mask:0xf
    v_add_f32_dpp v237, v237, v237 quad_perm:[2,3,0,1] row_mask:0xf bank_mask:0xf
    v_add_f32_dpp v238, v238, v238 quad_perm:[2,3,0,1] row_mask:0xf bank_mask:0xf
    v_add_f32_dpp v239, v239, v239 quad_perm:[2,3,0,1] row_mask:0xf bank_mask:0xf
    v_add_f32_dpp v232, v232, v232 quad_perm:[2,3,0,1] row_mask:0xf bank_mask:0xf
    v_add_f32_dpp v233, v233, v233 quad_perm:[2,3,0,1] row_mask:0xf bank_mask:0xf
    v_add_f32_dpp v234, v234, v234 quad_perm:[2,3,0,1] row_mask:0xf bank_mask:0xf
    v_add_f32_dpp v235, v235, v235 quad_perm:[2,3,0,1] row_mask:0xf bank_mask:0xf
    s_mov_b32 exec_lo, 0x110011
    s_mov_b32 exec_hi, 0x110011
    buffer_store_dwordx4 v[236:239], v29, s[48:51], s99 offen sc1
    buffer_store_dwordx4 v[232:235], v29, s[48:51], s98 offen sc1
    s_mov_b64 exec, -1
    s_cmp_lg_u32 s54, 3
    s_cbranch_scc1 END
    s_cmp_ge_u32 s55, 20
    s_cbranch_scc1 END
    v_lshrrev_b32 v7, 1, v1
    v_lshlrev_b32 v7, 7, v7
    v_and_b32 v3, 1, v1
    v_lshl_add_u32 v7, v3, 4, v7
    s_and_b32 s66, s55, 3
    s_lshl_b32 s3, s66, 5
    s_add_u32 s99, s3, 1179648
    s_lshl_b32 s66, s66, 3
    s_lshl_b32 s3, s56, 14
    s_add_u32 s99, s99, s3
    s_cmp_ge_u32 s55, 16
    s_cbranch_scc1 RED_SH
    s_lshr_b32 s3, s55, 2
    s_lshl_b32 s3, s3, 12
    s_add_u32 s99, s99, s3
    buffer_load_dwordx4 v[40:43], v7, s[48:51], s99 offen sc1
    s_lshr_b32 s3, s56, 2
    s_add_u32 s3, s3, s56
    s_lshl_b32 s3, s3, 7
    s_lshl_b32 s66, s55, 3
    s_add_u32 s3, s3, s66
    v_and_b32 v3, 1, v1
    v_mul_u32_u24 v3, 0x500, v3
    v_and_b32 v4, 1, v15
    v_lshl_add_u32 v3, v4, 2, v3
    v_lshrrev_b32 v4, 1, v15
    v_lshl_add_u32 v3, v4, 1, v3
P2_WAIT:
    s_waitcnt vmcnt(0)
    v_max3_u32 v4, v40, v41, v42
    v_mov_b32 v60, v40
    v_max_u32 v4, v4, v43
    v_mov_b32 v61, v41
    v_cmp_eq_u32 vcc, -1, v4
    v_mov_b32 v62, v42
    s_nop 0
    s_cbranch_vccnz P2_RETRY
    v_mov_b32 v63, v43
P2_OK:
    s_nop 0
    v_permlane32_swap_b32 v60, v61
    v_permlane32_swap_b32 v62, v63
    v_add_f32 v60, v60, v61
    v_add_f32 v62, v62, v63
    s_nop 1
    v_permlane16_swap_b32 v60, v62
    v_add_f32 v60, v60, v62
    s_nop 1
    v_add_f32_dpp v60, v60, v60 row_ror:8 row_mask:0xf bank_mask:0xf
    s_nop 1
    v_add_f32_dpp v60, v60, v60 row_ror:4 row_mask:0xf bank_mask:0xf
    s_nop 1
    v_add_f32_dpp v60, v60, v60 row_ror:2 row_mask:0xf bank_mask:0xf
    v_cvt_pk_bf16_f32 v60, v60, v60
    s_mov_b32 exec_lo, 0x30003
    s_mov_b32 exec_hi, 0x30003
    buffer_store_short v60, v3, s[40:43], s3 offen
    s_endpgm
VER_RETRY:
    s_cmp_eq_u32 s67, 0
    s_cbranch_scc1 VER_OK
    s_sub_u32 s67, s67, 1
    buffer_load_dword v34, v35, s[44:47], 0 offen offset:0 sc1
    s_waitcnt vmcnt(0)
    s_branch VER_CHK
REPUB:
    s_lshl_b32 s3, s55, 3
    s_add_u32 s3, s3, s56
    s_mul_i32 s3, s3, 2304
    s_lshl_b32 s66, s54, 6
    s_add_u32 s3, s3, s66
    s_add_u32 s3, s3, 2097152
    s_add_u32 s97, s97, 2097152
    s_add_u32 s65, s65, 2097152
    s_mov_b32 exec_lo, 0x110011
    s_mov_b32 exec_hi, 0x110011
    buffer_store_dwordx4 a[192:195], v10, s[48:51], s3 offen offset:0 sc1
    buffer_store_dwordx4 a[196:199], v10, s[48:51], s3 offen offset:256 sc1
    buffer_store_dwordx4 a[200:203], v10, s[48:51], s3 offen offset:512 sc1
    s_cmp_eq_u32 s54, 3
    s_cbranch_scc1 REPUB_END
    buffer_store_dwordx4 a[204:207], v11, s[48:51], s3 offen offset:1536 sc1
    buffer_store_dwordx4 a[208:211], v11, s[48:51], s3 offen offset:1920 sc1
REPUB_END:
    s_mov_b64 exec, -1
    s_waitcnt vmcnt(0)
    s_branch REPUB_OK
FC_RETRY0:
    s_sub_u32 s53, s53, 1
    s_cbranch_scc1 FC_OK0
    buffer_load_dword v13, v12, s[48:51], 0 offen offset:0 sc1
    s_waitcnt vmcnt(0)
    s_branch FC_LOOP0
GA_RETRY:
    s_cmp_eq_u32 s67, 0
    s_cbranch_scc1 GA_OK
    s_sub_u32 s67, s67, 1
    buffer_load_dwordx4 v[36:39], v30, s[48:51], s97 offen sc1
    buffer_load_dwordx4 v[40:43], v31, s[48:51], s97 offen sc1
    buffer_load_dwordx4 v[44:47], v32, s[48:51], s97 offen sc1
    s_waitcnt vmcnt(0)
    s_branch GA_CHK
FC_RETRY1:
    s_sub_u32 s53, s53, 1
    s_cbranch_scc1 FC_OK1
    buffer_load_dword v13, v12, s[48:51], 0 offen offset:1024 sc1
    s_waitcnt vmcnt(0)
    s_branch FC_LOOP1
H1_FAR:
    buffer_store_dwordx4 v[40:43], v30, s[48:51], s65 offen sc1
    s_branch JOIN3
ML_FAR:
    buffer_store_dwordx4 v[40:43], off, s[48:51], s3 offset:384 sc1
    s_branch JOIN3
P1_RETRY:
    s_mov_b64 exec, vcc
P1_LOOP:
    s_cmp_eq_u32 s67, 0
    s_cbranch_scc1 P1_DONE
    s_sub_u32 s67, s67, 1
    buffer_load_dwordx4 v[44:47], v25, s[48:51], s65 offen sc1
    s_waitcnt vmcnt(0)
    v_max3_u32 v3, v44, v45, v46
    v_max_u32 v3, v3, v47
    v_cmp_eq_u32 vcc, -1, v3
    s_cbranch_vccz P1_DONE
    s_mov_b64 exec, vcc
    s_branch P1_LOOP
P1_DONE:
    s_mov_b64 exec, -1
    s_branch P1_OK
RED_SH:
    s_add_u32 s99, s99, 131072
    v_add_u32 v53, 4096, v7
    v_add_u32 v54, 8192, v7
    v_add_u32 v55, 12288, v7
    buffer_load_dwordx4 v[36:39], v7, s[48:51], s99 offen sc1
    buffer_load_dwordx4 v[40:43], v53, s[48:51], s99 offen sc1
    buffer_load_dwordx4 v[44:47], v54, s[48:51], s99 offen sc1
    buffer_load_dwordx4 v[48:51], v55, s[48:51], s99 offen sc1
    s_lshr_b32 s3, s56, 2
    s_mul_i32 s3, s3, 640
    s_add_u32 s3, s3, s66
    s_and_b32 s66, s56, 3
    s_lshl_b32 s66, s66, 5
    s_add_u32 s3, s3, s66
    s_add_u32 s3, s3, 512
    v_and_b32 v3, 1, v1
    v_mul_u32_u24 v3, 0x500, v3
    v_and_b32 v4, 1, v15
    v_lshl_add_u32 v3, v4, 2, v3
    v_lshrrev_b32 v4, 1, v15
    v_lshl_add_u32 v3, v4, 1, v3
    s_waitcnt vmcnt(0)
    v_max3_u32 v52, v36, v37, v38
    v_max3_u32 v56, v39, v40, v41
    v_max3_u32 v52, v52, v42, v43
    v_max3_u32 v56, v56, v44, v45
    v_max3_u32 v52, v52, v46, v47
    v_max3_u32 v56, v56, v48, v49
    v_max3_u32 v52, v52, v50, v51
    v_max_u32 v52, v52, v56
    v_cmp_eq_u32 vcc, -1, v52
    s_cbranch_vccnz SH_RETRY
    v_pk_add_f32 v[60:61], v[36:37], v[40:41]
    v_pk_add_f32 v[62:63], v[38:39], v[42:43]
    v_pk_add_f32 v[64:65], v[44:45], v[48:49]
    v_pk_add_f32 v[66:67], v[46:47], v[50:51]
    s_nop 0
    v_pk_add_f32 v[60:61], v[60:61], v[64:65]
    v_pk_add_f32 v[62:63], v[62:63], v[66:67]
    s_nop 0
    s_branch P2_OK
SH_RETRY:
    s_mov_b64 exec, vcc
    buffer_load_dwordx4 v[36:39], v7, s[48:51], s99 offen sc1
    buffer_load_dwordx4 v[40:43], v53, s[48:51], s99 offen sc1
    buffer_load_dwordx4 v[44:47], v54, s[48:51], s99 offen sc1
    buffer_load_dwordx4 v[48:51], v55, s[48:51], s99 offen sc1
SH_LOOP:
    s_cmp_eq_u32 s67, 0
    s_cbranch_scc1 SH_DONE
    s_sub_u32 s67, s67, 1
    buffer_load_dwordx4 v[36:39], v7, s[48:51], s99 offen sc1
    buffer_load_dwordx4 v[40:43], v53, s[48:51], s99 offen sc1
    buffer_load_dwordx4 v[44:47], v54, s[48:51], s99 offen sc1
    buffer_load_dwordx4 v[48:51], v55, s[48:51], s99 offen sc1
    s_waitcnt vmcnt(4)
    v_max3_u32 v52, v36, v37, v38
    v_max3_u32 v52, v52, v39, v40
    v_max3_u32 v52, v52, v41, v42
    v_max3_u32 v52, v52, v43, v44
    v_max3_u32 v52, v52, v45, v46
    v_max3_u32 v52, v52, v47, v48
    v_max3_u32 v52, v52, v49, v50
    v_max_u32 v52, v52, v51
    v_cmp_eq_u32 vcc, -1, v52
    s_cbranch_vccz SH_DONE
    s_mov_b64 exec, vcc
    s_branch SH_LOOP
SH_DONE:
    s_mov_b64 exec, -1
    v_pk_add_f32 v[60:61], v[36:37], v[40:41]
    v_pk_add_f32 v[62:63], v[38:39], v[42:43]
    v_pk_add_f32 v[64:65], v[44:45], v[48:49]
    v_pk_add_f32 v[66:67], v[46:47], v[50:51]
    s_nop 0
    v_pk_add_f32 v[60:61], v[60:61], v[64:65]
    v_pk_add_f32 v[62:63], v[62:63], v[66:67]
    s_nop 0
    s_branch P2_OK
P2_RETRY:
    s_mov_b64 exec, vcc
    buffer_load_dwordx4 v[40:43], v7, s[48:51], s99 offen sc1
P2_LOOP:
    s_cmp_eq_u32 s67, 0
    s_cbranch_scc1 P2_DONE
    s_sub_u32 s67, s67, 1
    buffer_load_dwordx4 v[40:43], v7, s[48:51], s99 offen sc1
    s_waitcnt vmcnt(1)
    v_max3_u32 v4, v40, v41, v42
    v_max_u32 v4, v4, v43
    v_cmp_eq_u32 vcc, -1, v4
    s_cbranch_vccz P2_DONE
    s_mov_b64 exec, vcc
    s_branch P2_LOOP
P2_DONE:
    s_mov_b64 exec, -1
    v_mov_b32 v60, v40
    v_mov_b32 v61, v41
    v_mov_b32 v62, v42
    v_mov_b32 v63, v43
    s_branch P2_OK
END:
    s_endpgm
.section .rodata,"a"
.p2align 6
.amdhsa_kernel gated_mix__sliding_block_cached__swiglu_ffn__decode_kernel
  .amdhsa_next_free_vgpr 512
  .amdhsa_next_free_sgpr 102
  .amdhsa_accum_offset 256
  .amdhsa_group_segment_fixed_size 0
  .amdhsa_kernarg_size 104
  .amdhsa_user_sgpr_count 2
  .amdhsa_user_sgpr_kernarg_segment_ptr 1
  .amdhsa_system_sgpr_workgroup_id_x 1
  .amdhsa_float_denorm_mode_32 3
.end_amdhsa_kernel
```
